```python
import torch

def _softmax(x, axis=-1):
    return torch.softmax(x, dim=axis)
def _gelu(x):
    return torch.nn.functional.gelu(x, approximate="tanh")
def _silu(x):
    return torch.nn.functional.silu(x)
def _sigmoid(x):
    return torch.sigmoid(x)
def _layernorm(x, axis=-1, eps=1e-5):
    m = x.mean(dim=axis, keepdim=True)
    v = x.var(dim=axis, keepdim=True, unbiased=False)
    return (x - m) / torch.sqrt(v + eps)
def _scatter_add(tgt, idx, src, axis=0):
    return tgt.clone().index_add_(axis, idx, src)
def _segment_sum(src, seg, n):
    out = torch.zeros((n,) + src.shape[1:], dtype=src.dtype)
    return out.index_add_(0, seg, src)
def _pad(x, pw):
    flat = tuple(v for pair in reversed(pw) for v in pair)
    return torch.nn.functional.pad(x, flat)

kernel_name = 'standalone__gqa_block_cached__near_ridge'

def setup_inputs():

    _w = (lambda a: (lambda t: t.to(torch.bfloat16) if t.is_floating_point() else t)(torch.as_tensor(a)))
    B, Sq, D = 8, 64, 576
    Hq, Hkv, Sk, Dh = 32, 16, 2048, 128
    assert Hq % Hkv == 0, (Hq, Hkv)
    return {
        "x": _w((lambda *s: torch.randn(*s, dtype=torch.bfloat16) * 0.8)(B, Sq, D)),
        "k_cache": _w((lambda *s: torch.randn(*s, dtype=torch.bfloat16) * 0.8)(B, Hkv, Sk, Dh)),
        "v_cache": _w((lambda *s: torch.randn(*s, dtype=torch.bfloat16) * 0.05)(B, Hkv, Sk, Dh)),
        "wq": _w((lambda *s: torch.randn(*s, dtype=torch.bfloat16) * 0.8)(D, Hq * Dh) * (D ** -0.5)),
        "wo": _w((lambda *s: torch.randn(*s, dtype=torch.bfloat16) * 0.05)(Hq * Dh, D) * ((Hq * Dh) ** -0.5)),
    }

def reference(x, k_cache, v_cache, wq, wo):
    B, Sq, D = x.shape
    Hq, Dh = 32, 128
    Hkv = k_cache.shape[1]
    rep = Hq // Hkv
    q = (lambda x, *d: x.permute(*d))((x @ wq).reshape(B, Sq, Hq, Dh), 0, 2, 1, 3)
    k = (lambda x, n, axis: torch.repeat_interleave(x, n, dim=axis))(k_cache, rep, axis=1)
    v = (lambda x, n, axis: torch.repeat_interleave(x, n, dim=axis))(v_cache, rep, axis=1)
    scores = torch.einsum("bhqd,bhkd->bhqk", q, k) * (Dh ** -0.5)
    p = _softmax(scores, axis=-1)
    o = torch.einsum("bhqk,bhkd->bhqd", p, v)
    return (lambda x, *d: x.permute(*d))(o, 0, 2, 1, 3).reshape(B, Sq, Hq * Dh) @ wo
```

```asm
; @launch grid=(256,1,1) block=(512,1,1) lds=163840
.amdgcn_target "amdgcn-amd-amdhsa--gfx950"
.text
.globl standalone__gqa_block_cached__near_ridge_kernel
.p2align 8
.type standalone__gqa_block_cached__near_ridge_kernel,@function
standalone__gqa_block_cached__near_ridge_kernel:
  s_cmp_ge_u32 s2, 256
  s_cbranch_scc1 L_done
  s_load_dwordx16 s[16:31], s[0:1], 0
  v_and_b32 v1, 63, v0
  v_lshrrev_b32 v2, 6, v0
  s_and_b32 s9, s2, 7
  v_readfirstlane_b32 s3, v2
  s_lshl_b32 s9, s9, 2
  s_lshr_b32 s10, 0x72143650, s9
  s_and_b32 s10, s10, 7
  s_lshr_b32 s98, 0x55555555, s9
  s_and_b32 s98, s98, 15
  s_add_u32 s98, s98, 12
  s_lshr_b32 s8, s2, 3
  s_lshr_b32 s5, s8, 2
  s_and_b32 s11, s8, 3
  s_lshr_b32 s8, s10, 1
  s_lshl_b32 s8, s8, 2
  s_add_u32 s11, s11, s8
  s_lshr_b32 s4, s11, 1
  s_and_b32 s6, s11, 1
  s_lshl_b32 s6, s6, 1
  s_and_b32 s10, s10, 1
  s_add_u32 s6, s6, s10
  s_sub_u32 s8, 32, s98
  s_cmp_eq_u32 s10, 0
  s_cselect_b32 s15, s98, s8
  s_cselect_b32 s98, 0, s98
  s_lshl_b32 s98, s98, 14
  s_lshl_b32 s12, s5, 4
  s_add_u32 s12, s12, s11
  s_lshl_b32 s12, s12, 19
  s_sub_u32 s100, 16, s15
  s_and_b32 s7, s100, 3
  s_lshl_b32 s99, s7, 15
  s_add_u32 s96, s7, 2
  s_and_b32 s96, s96, 3
  s_lshl_b32 s96, s96, 15
  s_cmp_eq_u32 s7, 1
  s_cselect_b32 s97, 0, 131072
  s_mul_i32 s13, s5, 73728
  s_lshl_b32 s14, s11, 1
  s_and_b32 s8, s6, 1
  s_add_u32 s14, s14, s8
  s_lshl_b32 s14, s14, 8
  s_and_b32 s8, s3, 3
  s_lshl_b32 s8, s8, 17
  s_add_u32 s14, s14, s8
  s_and_b32 s8, s3, 1
  s_mul_i32 s8, s8, 36864
  s_sub_u32 s15, 73728, s8
  s_add_u32 s13, s13, s8
  v_lshrrev_b32 v20, 4, v1
  v_and_b32 v21, 15, v1
  v_lshlrev_b32 v22, 2, v20
  v_xor_b32 v21, v21, v22
  v_lshlrev_b32 v22, 8, v20
  v_lshlrev_b32 v23, 13, v20
  v_mul_u32_u24 v32, 1152, v20
  v_xor_b32 v40, 0, v21
  v_lshl_add_u32 v35, v40, 4, v32
  v_lshl_add_u32 v40, v40, 4, v23
  v_xor_b32 v41, 1, v21
  v_lshl_add_u32 v36, v41, 4, v32
  v_lshl_add_u32 v41, v41, 4, v23
  v_xor_b32 v42, 2, v21
  v_lshl_add_u32 v37, v42, 4, v32
  v_lshl_add_u32 v42, v42, 4, v23
  v_xor_b32 v43, 3, v21
  v_lshl_add_u32 v38, v43, 4, v32
  v_lshl_add_u32 v43, v43, 4, v23
  s_and_b32 s8, s3, 1
  s_lshl_b32 s8, s8, 1
  v_xor_b32 v21, s8, v21
  v_xor_b32 v18, 0, v21
  v_lshl_add_u32 v18, v18, 4, v22
  v_xor_b32 v19, 1, v21
  v_lshl_add_u32 v19, v19, 4, v22
  v_lshrrev_b32 v21, 3, v1
  v_mul_u32_u24 v21, 1152, v21
  v_and_b32 v22, 7, v1
  v_xor_b32 v22, v22, v20
  v_lshl_add_u32 v44, v22, 4, v21
  v_xor_b32 v22, 4, v22
  v_lshl_add_u32 v45, v22, 4, v21
  v_lshrrev_b32 v21, 1, v1
  v_mul_u32_u24 v21, 1152, v21
  v_and_b32 v22, 1, v1
  v_lshl_add_u32 v32, v22, 4, v21
  v_lshlrev_b32 v31, 4, v1
  s_waitcnt lgkmcnt(0)
  s_add_u32 s40, s16, s13
  s_addc_u32 s41, s17, 0
  s_mov_b32 s42, s15
  s_mov_b32 s43, 0x20000
  s_sub_u32 s8, 0x480000, s14
  s_add_u32 s44, s22, s14
  s_addc_u32 s45, s23, 0
  s_mov_b32 s46, s8
  s_mov_b32 s47, 0x20000
  s_add_u32 s32, s18, s12
  s_addc_u32 s33, s19, 0
  s_mov_b32 s34, 0x80000
  s_mov_b32 s35, 0x20000
  s_add_u32 s36, s20, s12
  s_addc_u32 s37, s21, 0
  s_mov_b32 s38, 0x80000
  s_mov_b32 s39, 0x20000
  s_mov_b32 s48, s24
  s_mov_b32 s49, s25
  s_mov_b32 s50, 0x480000
  s_mov_b32 s51, 0x20000
  s_mov_b32 s52, s26
  s_mov_b32 s53, s27
  s_mov_b32 s54, 0x90000
  s_mov_b32 s55, 0x20000
  s_mov_b32 s56, s30
  s_mov_b32 s57, s31
  s_mov_b32 s58, 0x10000000
  s_mov_b32 s59, 0x20000
  s_mov_b32 s60, s28
  s_mov_b32 s61, s29
  s_mov_b32 s62, 0x100
  s_mov_b32 s63, 0x20000
  s_lshl_b32 s26, s3, 11
  s_and_b32 s17, s3, 3
  s_lshr_b32 s18, s3, 2
  s_and_b32 s16, s4, 1
  s_lshl_b32 s16, s16, 1
  s_lshr_b32 s8, s6, 1
  s_add_u32 s16, s16, s8
  s_lshl_b32 s16, s16, 1
  s_add_u32 s16, s16, s5
  s_sub_u32 s8, s16, 9
  s_cmp_ge_u32 s16, 9
  s_cselect_b32 s16, s8, s16
  s_cmp_gt_u32 s3, 5
  s_cbranch_scc1 L_cl0_e
  s_lshl_b32 s10, s17, 12
  s_cmp_gt_u32 s3, 3
  s_cbranch_scc1 L_cl0_x
  s_lshl_b32 s9, s16, 19
  s_add_u32 s10, s10, s96
  s_add_u32 m0, s10, 0
  s_add_u32 s8, s9, 0
  buffer_load_dwordx4 v40, s[44:47], s8 offen lds
  s_add_u32 m0, s10, 1024
  s_add_u32 s8, s9, 32768
  buffer_load_dwordx4 v41, s[44:47], s8 offen lds
  s_add_u32 m0, s10, 2048
  s_add_u32 s8, s9, 65536
  buffer_load_dwordx4 v42, s[44:47], s8 offen lds
  s_add_u32 m0, s10, 3072
  s_add_u32 s8, s9, 98304
  buffer_load_dwordx4 v43, s[44:47], s8 offen lds
  s_branch L_cl0_a
L_cl0_x:
  s_lshl_b32 s9, s16, 7
  s_add_u32 s10, s10, s97
  s_add_u32 m0, s10, 0
  s_add_u32 s8, s9, 0
  buffer_load_dwordx4 v44, s[40:43], s8 offen lds
  s_add_u32 m0, s10, 1024
  s_add_u32 s8, s9, 9216
  buffer_load_dwordx4 v45, s[40:43], s8 offen lds
  s_add_u32 m0, s10, 2048
  s_add_u32 s8, s9, 18432
  buffer_load_dwordx4 v44, s[40:43], s8 offen lds
  s_add_u32 m0, s10, 3072
  s_add_u32 s8, s9, 27648
  buffer_load_dwordx4 v45, s[40:43], s8 offen lds
L_cl0_a:
  s_add_u32 s16, s16, 1
  s_cmp_eq_u32 s16, 9
  s_cselect_b32 s16, 0, s16
L_cl0_e:
  s_cmp_gt_u32 s3, 5
  s_cbranch_scc1 L_cl1_e
  s_lshl_b32 s10, s17, 12
  s_cmp_gt_u32 s3, 3
  s_cbranch_scc1 L_cl1_x
  s_lshl_b32 s9, s16, 19
  s_add_u32 s10, s10, s96
  s_add_u32 m0, s10, 16384
  s_add_u32 s8, s9, 0
  buffer_load_dwordx4 v40, s[44:47], s8 offen lds
  s_add_u32 m0, s10, 17408
  s_add_u32 s8, s9, 32768
  buffer_load_dwordx4 v41, s[44:47], s8 offen lds
  s_add_u32 m0, s10, 18432
  s_add_u32 s8, s9, 65536
  buffer_load_dwordx4 v42, s[44:47], s8 offen lds
  s_add_u32 m0, s10, 19456
  s_add_u32 s8, s9, 98304
  buffer_load_dwordx4 v43, s[44:47], s8 offen lds
  s_branch L_cl1_a
L_cl1_x:
  s_lshl_b32 s9, s16, 7
  s_add_u32 s10, s10, s97
  s_add_u32 m0, s10, 8192
  s_add_u32 s8, s9, 0
  buffer_load_dwordx4 v44, s[40:43], s8 offen lds
  s_add_u32 m0, s10, 9216
  s_add_u32 s8, s9, 9216
  buffer_load_dwordx4 v45, s[40:43], s8 offen lds
  s_add_u32 m0, s10, 10240
  s_add_u32 s8, s9, 18432
  buffer_load_dwordx4 v44, s[40:43], s8 offen lds
  s_add_u32 m0, s10, 11264
  s_add_u32 s8, s9, 27648
  buffer_load_dwordx4 v45, s[40:43], s8 offen lds
L_cl1_a:
  s_add_u32 s16, s16, 1
  s_cmp_eq_u32 s16, 9
  s_cselect_b32 s16, 0, s16
L_cl1_e:
  s_cmp_gt_u32 s3, 5
  s_cbranch_scc1 L_cl2_e
  s_lshl_b32 s10, s17, 12
  s_cmp_gt_u32 s3, 3
  s_cbranch_scc1 L_cl2_x
  s_lshl_b32 s9, s16, 19
  s_add_u32 s10, s10, s96
  s_add_u32 m0, s10, 32768
  s_add_u32 s8, s9, 0
  buffer_load_dwordx4 v40, s[44:47], s8 offen lds
  s_add_u32 m0, s10, 33792
  s_add_u32 s8, s9, 32768
  buffer_load_dwordx4 v41, s[44:47], s8 offen lds
  s_add_u32 m0, s10, 34816
  s_add_u32 s8, s9, 65536
  buffer_load_dwordx4 v42, s[44:47], s8 offen lds
  s_add_u32 m0, s10, 35840
  s_add_u32 s8, s9, 98304
  buffer_load_dwordx4 v43, s[44:47], s8 offen lds
  s_branch L_cl2_a
L_cl2_x:
  s_lshl_b32 s9, s16, 7
  s_add_u32 s10, s10, s97
  s_add_u32 m0, s10, 16384
  s_add_u32 s8, s9, 0
  buffer_load_dwordx4 v44, s[40:43], s8 offen lds
  s_add_u32 m0, s10, 17408
  s_add_u32 s8, s9, 9216
  buffer_load_dwordx4 v45, s[40:43], s8 offen lds
  s_add_u32 m0, s10, 18432
  s_add_u32 s8, s9, 18432
  buffer_load_dwordx4 v44, s[40:43], s8 offen lds
  s_add_u32 m0, s10, 19456
  s_add_u32 s8, s9, 27648
  buffer_load_dwordx4 v45, s[40:43], s8 offen lds
L_cl2_a:
  s_add_u32 s16, s16, 1
  s_cmp_eq_u32 s16, 9
  s_cselect_b32 s16, 0, s16
L_cl2_e:
  s_lshl_b32 s21, s5, 3
  s_add_u32 s21, s21, s4
  s_lshl_b32 s22, s5, 2
  s_add_u32 s22, s22, s6
  s_lshl_b32 s28, s5, 14
  s_add_u32 s28, s28, 0x1500000
  s_mov_b32 s7, 0x3e0293ee
  s_cmp_eq_u32 s4, s5
  s_cselect_b32 s25, s6, 1
  s_xor_b32 s8, s3, 7
  s_or_b32 s25, s25, s8
  s_cmp_lg_u32 s25, 0
  s_cbranch_scc1 L_noclr
  v_mov_b32 v128, 0
  v_lshlrev_b32 v129, 7, v1
  s_add_u32 s8, s28, 8192
  buffer_store_dword v128, v129, s[56:59], s28 offen sc1
  buffer_store_dword v128, v129, s[56:59], s8 offen sc1
L_noclr:
  v_and_b32 v132, 31, v1
  v_lshrrev_b32 v133, 5, v1
  v_bfe_u32 v134, v1, 4, 1
  v_bfe_u32 v135, v1, 2, 2
  v_and_b32 v136, 3, v1
  v_lshl_add_u32 v20, v133, 3, v135
  v_lshlrev_b32 v20, 8, v20
  v_add_u32 v20, s96, v20
  v_lshrrev_b32 v21, 1, v136
  v_lshl_add_u32 v20, v21, 3, v20
  v_xor_b32 v21, s17, v135
  v_lshl_add_u32 v20, v21, 6, v20
  v_and_b32 v21, 1, v136
  v_lshl_add_u32 v21, v134, 1, v21
  v_lshlrev_b32 v22, 1, v133
  v_xor_b32 v21, v21, v22
  v_lshl_add_u32 v48, v21, 4, v20
  v_xor_b32 v21, 1, v21
  v_lshl_add_u32 v49, v21, 4, v20
  v_add_u32 v49, 1024, v49
  s_lshl_b32 s8, s18, 12
  s_add_u32 s8, s8, s97
  v_lshlrev_b32 v20, 7, v132
  v_add_u32 v20, s8, v20
  v_bfe_u32 v21, v132, 1, 3
  v_xor_b32 v21, v21, v133
  v_xor_b32 v52, 0, v21
  v_lshl_add_u32 v52, v52, 4, v20
  v_xor_b32 v53, 2, v21
  v_lshl_add_u32 v53, v53, 4, v20
  v_xor_b32 v54, 4, v21
  v_lshl_add_u32 v54, v54, 4, v20
  v_xor_b32 v55, 6, v21
  v_lshl_add_u32 v55, v55, 4, v20
  s_lshl_b32 s8, s18, 1
  v_xor_b32 v23, s8, v135
  s_lshl_b32 s8, s18, 13
  s_add_u32 s8, s8, s99
  v_and_b32 v20, 3, v132
  v_lshlrev_b32 v20, 2, v20
  v_bfe_u32 v21, v132, 2, 2
  v_or_b32 v20, v20, v21
  v_xor_b32 v20, v20, v133
  v_lshlrev_b32 v21, 8, v132
  v_add_u32 v21, s8, v21
  v_xor_b32 v2, 0, v20
  v_lshl_add_u32 v2, v2, 4, v21
  v_xor_b32 v3, 2, v20
  v_lshl_add_u32 v3, v3, 4, v21
  v_xor_b32 v4, 4, v20
  v_lshl_add_u32 v4, v4, 4, v21
  v_xor_b32 v5, 6, v20
  v_lshl_add_u32 v5, v5, 4, v21
  v_xor_b32 v6, 8, v20
  v_lshl_add_u32 v6, v6, 4, v21
  v_xor_b32 v7, 10, v20
  v_lshl_add_u32 v7, v7, 4, v21
  v_xor_b32 v8, 12, v20
  v_lshl_add_u32 v8, v8, 4, v21
  v_xor_b32 v9, 14, v20
  v_lshl_add_u32 v9, v9, 4, v21
  v_lshl_add_u32 v20, v133, 2, v135
  v_lshlrev_b32 v33, 5, v20
  v_lshlrev_b32 v20, 8, v20
  v_add_u32 v20, s8, v20
  v_and_b32 v21, 1, v136
  v_lshl_add_u32 v20, v21, 3, v20
  v_lshrrev_b32 v21, 1, v136
  v_lshl_add_u32 v21, v134, 1, v21
  v_xor_b32 v21, v21, v133
  v_xor_b32 v10, 0, v21
  v_lshl_add_u32 v10, v10, 4, v20
  v_xor_b32 v22, 0, v23
  v_lshl_add_u32 v10, v22, 6, v10
  v_xor_b32 v11, 2, v21
  v_lshl_add_u32 v11, v11, 4, v20
  v_xor_b32 v22, 0, v23
  v_lshl_add_u32 v11, v22, 6, v11
  v_add_u32 v11, 2048, v11
  v_xor_b32 v12, 0, v21
  v_lshl_add_u32 v12, v12, 4, v20
  v_xor_b32 v22, 1, v23
  v_lshl_add_u32 v12, v22, 6, v12
  v_xor_b32 v13, 2, v21
  v_lshl_add_u32 v13, v13, 4, v20
  v_xor_b32 v22, 1, v23
  v_lshl_add_u32 v13, v22, 6, v13
  v_add_u32 v13, 2048, v13
  v_xor_b32 v14, 0, v21
  v_lshl_add_u32 v14, v14, 4, v20
  v_xor_b32 v22, 2, v23
  v_lshl_add_u32 v14, v22, 6, v14
  v_xor_b32 v15, 2, v21
  v_lshl_add_u32 v15, v15, 4, v20
  v_xor_b32 v22, 2, v23
  v_lshl_add_u32 v15, v22, 6, v15
  v_add_u32 v15, 2048, v15
  v_xor_b32 v16, 0, v21
  v_lshl_add_u32 v16, v16, 4, v20
  v_xor_b32 v22, 3, v23
  v_lshl_add_u32 v16, v22, 6, v16
  v_xor_b32 v17, 2, v21
  v_lshl_add_u32 v17, v17, 4, v20
  v_xor_b32 v22, 3, v23
  v_lshl_add_u32 v17, v22, 6, v17
  v_add_u32 v17, 2048, v17
  v_lshl_add_u32 v33, v136, 3, v33
  s_lshl_b32 s8, s17, 10
  s_lshl_b32 s29, s18, 13
  s_add_u32 s29, s29, s8
  s_add_u32 s8, s8, 131072
  v_add_u32 v33, s8, v33
  s_lshl_b32 s8, s17, 13
  s_lshl_b32 s27, s18, 12
  s_add_u32 s27, s27, s8
  s_mul_i32 s19, s6, 144
  s_lshl_b32 s20, s4, 9
  s_lshl_b32 s8, s17, 5
  s_add_u32 s20, s20, s8
  s_lshl_b32 s8, s18, 8
  s_add_u32 s30, s20, s8
  s_lshl_b32 s8, s18, 4
  s_add_u32 s20, s20, s8
  s_mul_i32 s20, s20, 1152
  s_mul_i32 s30, s30, 1152
  s_lshl_b32 s8, s19, 1
  s_add_u32 s20, s20, s8
  s_add_u32 s30, s30, s8
  s_add_u32 s30, s30, 256
  v_mov_b32 v23, 0
  s_cmp_lg_u32 s25, 0
  s_cbranch_scc1 L_noann
  v_mov_b32 v20, 1
  s_lshl_b32 s8, s5, 2
  s_waitcnt vmcnt(0)
  s_mov_b64 exec, 1
  buffer_store_dword v20, v23, s[60:63], s8 offen sc1
  s_mov_b64 exec, -1
L_noann:
  s_waitcnt vmcnt(8)
  s_barrier
  ds_read_b128 a[48:51], v52 offset:0
  ds_read_b64_tr_b16 a[32:33], v48 offset:0
  ds_read_b64_tr_b16 a[34:35], v49 offset:0
  ds_read_b128 a[52:55], v53 offset:0
  ds_read_b64_tr_b16 a[36:37], v48 offset:4096
  ds_read_b64_tr_b16 a[38:39], v49 offset:4096
  ds_read_b128 a[56:59], v54 offset:0
  ds_read_b64_tr_b16 a[40:41], v48 offset:8192
  ds_read_b64_tr_b16 a[42:43], v49 offset:8192
  ds_read_b128 a[60:63], v55 offset:0
  ds_read_b64_tr_b16 a[44:45], v48 offset:12288
  ds_read_b64_tr_b16 a[46:47], v49 offset:12288
  s_cmp_gt_u32 s3, 5
  s_cbranch_scc1 L_cl3_e
  s_lshl_b32 s10, s17, 12
  s_cmp_gt_u32 s3, 3
  s_cbranch_scc1 L_cl3_x
  s_lshl_b32 s9, s16, 19
  s_add_u32 s10, s10, s96
  s_add_u32 m0, s10, 49152
  s_add_u32 s8, s9, 0
  buffer_load_dwordx4 v40, s[44:47], s8 offen lds
  s_add_u32 m0, s10, 50176
  s_add_u32 s8, s9, 32768
  buffer_load_dwordx4 v41, s[44:47], s8 offen lds
  s_add_u32 m0, s10, 51200
  s_add_u32 s8, s9, 65536
  buffer_load_dwordx4 v42, s[44:47], s8 offen lds
  s_add_u32 m0, s10, 52224
  s_add_u32 s8, s9, 98304
  buffer_load_dwordx4 v43, s[44:47], s8 offen lds
  s_branch L_cl3_a
L_cl3_x:
  s_lshl_b32 s9, s16, 7
  s_add_u32 s10, s10, s97
  s_add_u32 m0, s10, 24576
  s_add_u32 s8, s9, 0
  buffer_load_dwordx4 v44, s[40:43], s8 offen lds
  s_add_u32 m0, s10, 25600
  s_add_u32 s8, s9, 9216
  buffer_load_dwordx4 v45, s[40:43], s8 offen lds
  s_add_u32 m0, s10, 26624
  s_add_u32 s8, s9, 18432
  buffer_load_dwordx4 v44, s[40:43], s8 offen lds
  s_add_u32 m0, s10, 27648
  s_add_u32 s8, s9, 27648
  buffer_load_dwordx4 v45, s[40:43], s8 offen lds
L_cl3_a:
  s_add_u32 s16, s16, 1
  s_cmp_eq_u32 s16, 9
  s_cselect_b32 s16, 0, s16
L_cl3_e:
  s_waitcnt vmcnt(8)
  s_waitcnt lgkmcnt(0)
  s_barrier
  v_mfma_f32_32x32x16_bf16 v[64:79], a[32:35], a[48:51], 0
  ds_read_b128 a[80:83], v52 offset:8192
  ds_read_b64_tr_b16 a[64:65], v48 offset:16384
  ds_read_b64_tr_b16 a[66:67], v49 offset:16384
  ds_read_b128 a[84:87], v53 offset:8192
  ds_read_b64_tr_b16 a[68:69], v48 offset:20480
  ds_read_b64_tr_b16 a[70:71], v49 offset:20480
  v_mfma_f32_32x32x16_bf16 v[64:79], a[36:39], a[52:55], v[64:79]
  ds_read_b128 a[88:91], v54 offset:8192
  ds_read_b64_tr_b16 a[72:73], v48 offset:24576
  ds_read_b64_tr_b16 a[74:75], v49 offset:24576
  ds_read_b128 a[92:95], v55 offset:8192
  ds_read_b64_tr_b16 a[76:77], v48 offset:28672
  ds_read_b64_tr_b16 a[78:79], v49 offset:28672
  s_cmp_gt_u32 s3, 5
  s_cbranch_scc1 L_cl4_e
  s_lshl_b32 s10, s17, 12
  s_cmp_gt_u32 s3, 3
  s_cbranch_scc1 L_cl4_x
  s_lshl_b32 s9, s16, 19
  s_add_u32 s10, s10, s96
  s_add_u32 m0, s10, 0
  s_add_u32 s8, s9, 0
  buffer_load_dwordx4 v40, s[44:47], s8 offen lds
  s_add_u32 m0, s10, 1024
  s_add_u32 s8, s9, 32768
  buffer_load_dwordx4 v41, s[44:47], s8 offen lds
  s_add_u32 m0, s10, 2048
  s_add_u32 s8, s9, 65536
  buffer_load_dwordx4 v42, s[44:47], s8 offen lds
  s_add_u32 m0, s10, 3072
  s_add_u32 s8, s9, 98304
  buffer_load_dwordx4 v43, s[44:47], s8 offen lds
  s_branch L_cl4_a
L_cl4_x:
  s_lshl_b32 s9, s16, 7
  s_add_u32 s10, s10, s97
  s_add_u32 m0, s10, 0
  s_add_u32 s8, s9, 0
  buffer_load_dwordx4 v44, s[40:43], s8 offen lds
  s_add_u32 m0, s10, 1024
  s_add_u32 s8, s9, 9216
  buffer_load_dwordx4 v45, s[40:43], s8 offen lds
  s_add_u32 m0, s10, 2048
  s_add_u32 s8, s9, 18432
  buffer_load_dwordx4 v44, s[40:43], s8 offen lds
  s_add_u32 m0, s10, 3072
  s_add_u32 s8, s9, 27648
  buffer_load_dwordx4 v45, s[40:43], s8 offen lds
L_cl4_a:
  s_add_u32 s16, s16, 1
  s_cmp_eq_u32 s16, 9
  s_cselect_b32 s16, 0, s16
L_cl4_e:
  v_mfma_f32_32x32x16_bf16 v[64:79], a[40:43], a[56:59], v[64:79]
  v_mfma_f32_32x32x16_bf16 v[64:79], a[44:47], a[60:63], v[64:79]
  s_waitcnt vmcnt(8)
  s_waitcnt lgkmcnt(0)
  s_barrier
  v_mfma_f32_32x32x16_bf16 v[64:79], a[64:67], a[80:83], v[64:79]
  ds_read_b128 a[48:51], v52 offset:16384
  ds_read_b64_tr_b16 a[32:33], v48 offset:32768
  ds_read_b64_tr_b16 a[34:35], v49 offset:32768
  ds_read_b128 a[52:55], v53 offset:16384
  ds_read_b64_tr_b16 a[36:37], v48 offset:36864
  ds_read_b64_tr_b16 a[38:39], v49 offset:36864
  v_mfma_f32_32x32x16_bf16 v[64:79], a[68:71], a[84:87], v[64:79]
  ds_read_b128 a[56:59], v54 offset:16384
  ds_read_b64_tr_b16 a[40:41], v48 offset:40960
  ds_read_b64_tr_b16 a[42:43], v49 offset:40960
  ds_read_b128 a[60:63], v55 offset:16384
  ds_read_b64_tr_b16 a[44:45], v48 offset:45056
  ds_read_b64_tr_b16 a[46:47], v49 offset:45056
  s_cmp_gt_u32 s3, 5
  s_cbranch_scc1 L_cl5_e
  s_lshl_b32 s10, s17, 12
  s_cmp_gt_u32 s3, 3
  s_cbranch_scc1 L_cl5_x
  s_lshl_b32 s9, s16, 19
  s_add_u32 s10, s10, s96
  s_add_u32 m0, s10, 16384
  s_add_u32 s8, s9, 0
  buffer_load_dwordx4 v40, s[44:47], s8 offen lds
  s_add_u32 m0, s10, 17408
  s_add_u32 s8, s9, 32768
  buffer_load_dwordx4 v41, s[44:47], s8 offen lds
  s_add_u32 m0, s10, 18432
  s_add_u32 s8, s9, 65536
  buffer_load_dwordx4 v42, s[44:47], s8 offen lds
  s_add_u32 m0, s10, 19456
  s_add_u32 s8, s9, 98304
  buffer_load_dwordx4 v43, s[44:47], s8 offen lds
  s_branch L_cl5_a
L_cl5_x:
  s_lshl_b32 s9, s16, 7
  s_add_u32 s10, s10, s97
  s_add_u32 m0, s10, 8192
  s_add_u32 s8, s9, 0
  buffer_load_dwordx4 v44, s[40:43], s8 offen lds
  s_add_u32 m0, s10, 9216
  s_add_u32 s8, s9, 9216
  buffer_load_dwordx4 v45, s[40:43], s8 offen lds
  s_add_u32 m0, s10, 10240
  s_add_u32 s8, s9, 18432
  buffer_load_dwordx4 v44, s[40:43], s8 offen lds
  s_add_u32 m0, s10, 11264
  s_add_u32 s8, s9, 27648
  buffer_load_dwordx4 v45, s[40:43], s8 offen lds
L_cl5_a:
  s_add_u32 s16, s16, 1
  s_cmp_eq_u32 s16, 9
  s_cselect_b32 s16, 0, s16
L_cl5_e:
  v_mfma_f32_32x32x16_bf16 v[64:79], a[72:75], a[88:91], v[64:79]
  v_mfma_f32_32x32x16_bf16 v[64:79], a[76:79], a[92:95], v[64:79]
  s_waitcnt vmcnt(8)
  s_waitcnt lgkmcnt(0)
  s_barrier
  v_mfma_f32_32x32x16_bf16 v[64:79], a[32:35], a[48:51], v[64:79]
  ds_read_b128 a[80:83], v52 offset:24576
  ds_read_b64_tr_b16 a[64:65], v48 offset:49152
  ds_read_b64_tr_b16 a[66:67], v49 offset:49152
  ds_read_b128 a[84:87], v53 offset:24576
  ds_read_b64_tr_b16 a[68:69], v48 offset:53248
  ds_read_b64_tr_b16 a[70:71], v49 offset:53248
  v_mfma_f32_32x32x16_bf16 v[64:79], a[36:39], a[52:55], v[64:79]
  ds_read_b128 a[88:91], v54 offset:24576
  ds_read_b64_tr_b16 a[72:73], v48 offset:57344
  ds_read_b64_tr_b16 a[74:75], v49 offset:57344
  ds_read_b128 a[92:95], v55 offset:24576
  ds_read_b64_tr_b16 a[76:77], v48 offset:61440
  ds_read_b64_tr_b16 a[78:79], v49 offset:61440
  s_cmp_gt_u32 s3, 5
  s_cbranch_scc1 L_cl6_e
  s_lshl_b32 s10, s17, 12
  s_cmp_gt_u32 s3, 3
  s_cbranch_scc1 L_cl6_x
  s_lshl_b32 s9, s16, 19
  s_add_u32 s10, s10, s96
  s_add_u32 m0, s10, 32768
  s_add_u32 s8, s9, 0
  buffer_load_dwordx4 v40, s[44:47], s8 offen lds
  s_add_u32 m0, s10, 33792
  s_add_u32 s8, s9, 32768
  buffer_load_dwordx4 v41, s[44:47], s8 offen lds
  s_add_u32 m0, s10, 34816
  s_add_u32 s8, s9, 65536
  buffer_load_dwordx4 v42, s[44:47], s8 offen lds
  s_add_u32 m0, s10, 35840
  s_add_u32 s8, s9, 98304
  buffer_load_dwordx4 v43, s[44:47], s8 offen lds
  s_branch L_cl6_a
L_cl6_x:
  s_lshl_b32 s9, s16, 7
  s_add_u32 s10, s10, s97
  s_add_u32 m0, s10, 16384
  s_add_u32 s8, s9, 0
  buffer_load_dwordx4 v44, s[40:43], s8 offen lds
  s_add_u32 m0, s10, 17408
  s_add_u32 s8, s9, 9216
  buffer_load_dwordx4 v45, s[40:43], s8 offen lds
  s_add_u32 m0, s10, 18432
  s_add_u32 s8, s9, 18432
  buffer_load_dwordx4 v44, s[40:43], s8 offen lds
  s_add_u32 m0, s10, 19456
  s_add_u32 s8, s9, 27648
  buffer_load_dwordx4 v45, s[40:43], s8 offen lds
L_cl6_a:
  s_add_u32 s16, s16, 1
  s_cmp_eq_u32 s16, 9
  s_cselect_b32 s16, 0, s16
L_cl6_e:
  v_mfma_f32_32x32x16_bf16 v[64:79], a[40:43], a[56:59], v[64:79]
  v_mfma_f32_32x32x16_bf16 v[64:79], a[44:47], a[60:63], v[64:79]
  s_waitcnt vmcnt(8)
  s_waitcnt lgkmcnt(0)
  s_barrier
  v_mfma_f32_32x32x16_bf16 v[64:79], a[64:67], a[80:83], v[64:79]
  ds_read_b128 a[48:51], v52 offset:0
  ds_read_b64_tr_b16 a[32:33], v48 offset:0
  ds_read_b64_tr_b16 a[34:35], v49 offset:0
  ds_read_b128 a[52:55], v53 offset:0
  ds_read_b64_tr_b16 a[36:37], v48 offset:4096
  ds_read_b64_tr_b16 a[38:39], v49 offset:4096
  v_mfma_f32_32x32x16_bf16 v[64:79], a[68:71], a[84:87], v[64:79]
  ds_read_b128 a[56:59], v54 offset:0
  ds_read_b64_tr_b16 a[40:41], v48 offset:8192
  ds_read_b64_tr_b16 a[42:43], v49 offset:8192
  ds_read_b128 a[60:63], v55 offset:0
  ds_read_b64_tr_b16 a[44:45], v48 offset:12288
  ds_read_b64_tr_b16 a[46:47], v49 offset:12288
  s_cmp_gt_u32 s3, 5
  s_cbranch_scc1 L_cl7_e
  s_lshl_b32 s10, s17, 12
  s_cmp_gt_u32 s3, 3
  s_cbranch_scc1 L_cl7_x
  s_lshl_b32 s9, s16, 19
  s_add_u32 s10, s10, s96
  s_add_u32 m0, s10, 49152
  s_add_u32 s8, s9, 0
  buffer_load_dwordx4 v40, s[44:47], s8 offen lds
  s_add_u32 m0, s10, 50176
  s_add_u32 s8, s9, 32768
  buffer_load_dwordx4 v41, s[44:47], s8 offen lds
  s_add_u32 m0, s10, 51200
  s_add_u32 s8, s9, 65536
  buffer_load_dwordx4 v42, s[44:47], s8 offen lds
  s_add_u32 m0, s10, 52224
  s_add_u32 s8, s9, 98304
  buffer_load_dwordx4 v43, s[44:47], s8 offen lds
  s_branch L_cl7_a
L_cl7_x:
  s_lshl_b32 s9, s16, 7
  s_add_u32 s10, s10, s97
  s_add_u32 m0, s10, 24576
  s_add_u32 s8, s9, 0
  buffer_load_dwordx4 v44, s[40:43], s8 offen lds
  s_add_u32 m0, s10, 25600
  s_add_u32 s8, s9, 9216
  buffer_load_dwordx4 v45, s[40:43], s8 offen lds
  s_add_u32 m0, s10, 26624
  s_add_u32 s8, s9, 18432
  buffer_load_dwordx4 v44, s[40:43], s8 offen lds
  s_add_u32 m0, s10, 27648
  s_add_u32 s8, s9, 27648
  buffer_load_dwordx4 v45, s[40:43], s8 offen lds
L_cl7_a:
  s_add_u32 s16, s16, 1
  s_cmp_eq_u32 s16, 9
  s_cselect_b32 s16, 0, s16
L_cl7_e:
  v_mfma_f32_32x32x16_bf16 v[64:79], a[72:75], a[88:91], v[64:79]
  v_mfma_f32_32x32x16_bf16 v[64:79], a[76:79], a[92:95], v[64:79]
  s_waitcnt vmcnt(8)
  s_waitcnt lgkmcnt(0)
  s_barrier
  v_mfma_f32_32x32x16_bf16 v[64:79], a[32:35], a[48:51], v[64:79]
  ds_read_b128 a[80:83], v52 offset:8192
  ds_read_b64_tr_b16 a[64:65], v48 offset:16384
  ds_read_b64_tr_b16 a[66:67], v49 offset:16384
  ds_read_b128 a[84:87], v53 offset:8192
  ds_read_b64_tr_b16 a[68:69], v48 offset:20480
  ds_read_b64_tr_b16 a[70:71], v49 offset:20480
  v_mfma_f32_32x32x16_bf16 v[64:79], a[36:39], a[52:55], v[64:79]
  ds_read_b128 a[88:91], v54 offset:8192
  ds_read_b64_tr_b16 a[72:73], v48 offset:24576
  ds_read_b64_tr_b16 a[74:75], v49 offset:24576
  ds_read_b128 a[92:95], v55 offset:8192
  ds_read_b64_tr_b16 a[76:77], v48 offset:28672
  ds_read_b64_tr_b16 a[78:79], v49 offset:28672
  s_cmp_gt_u32 s3, 5
  s_cbranch_scc1 L_cl8_e
  s_lshl_b32 s10, s17, 12
  s_cmp_gt_u32 s3, 3
  s_cbranch_scc1 L_cl8_x
  s_lshl_b32 s9, s16, 19
  s_add_u32 s10, s10, s96
  s_add_u32 m0, s10, 0
  s_add_u32 s8, s9, 0
  buffer_load_dwordx4 v40, s[44:47], s8 offen lds
  s_add_u32 m0, s10, 1024
  s_add_u32 s8, s9, 32768
  buffer_load_dwordx4 v41, s[44:47], s8 offen lds
  s_add_u32 m0, s10, 2048
  s_add_u32 s8, s9, 65536
  buffer_load_dwordx4 v42, s[44:47], s8 offen lds
  s_add_u32 m0, s10, 3072
  s_add_u32 s8, s9, 98304
  buffer_load_dwordx4 v43, s[44:47], s8 offen lds
  s_branch L_cl8_a
L_cl8_x:
  s_lshl_b32 s9, s16, 7
  s_add_u32 s10, s10, s97
  s_add_u32 m0, s10, 0
  s_add_u32 s8, s9, 0
  buffer_load_dwordx4 v44, s[40:43], s8 offen lds
  s_add_u32 m0, s10, 1024
  s_add_u32 s8, s9, 9216
  buffer_load_dwordx4 v45, s[40:43], s8 offen lds
  s_add_u32 m0, s10, 2048
  s_add_u32 s8, s9, 18432
  buffer_load_dwordx4 v44, s[40:43], s8 offen lds
  s_add_u32 m0, s10, 3072
  s_add_u32 s8, s9, 27648
  buffer_load_dwordx4 v45, s[40:43], s8 offen lds
L_cl8_a:
  s_add_u32 s16, s16, 1
  s_cmp_eq_u32 s16, 9
  s_cselect_b32 s16, 0, s16
L_cl8_e:
  s_cmp_lg_u32 s3, 7
  s_cbranch_scc1 L_nohl
  s_lshl_b32 s8, s5, 2
  buffer_load_dword v34, v23, s[60:63], s8 offen sc1
L_nohl:
  v_mfma_f32_32x32x16_bf16 v[64:79], a[40:43], a[56:59], v[64:79]
  v_mfma_f32_32x32x16_bf16 v[64:79], a[44:47], a[60:63], v[64:79]
  s_waitcnt vmcnt(8)
  s_waitcnt lgkmcnt(0)
  s_barrier
  v_mfma_f32_32x32x16_bf16 v[64:79], a[64:67], a[80:83], v[64:79]
  ds_read_b128 a[48:51], v52 offset:16384
  ds_read_b64_tr_b16 a[32:33], v48 offset:32768
  ds_read_b64_tr_b16 a[34:35], v49 offset:32768
  ds_read_b128 a[52:55], v53 offset:16384
  ds_read_b64_tr_b16 a[36:37], v48 offset:36864
  ds_read_b64_tr_b16 a[38:39], v49 offset:36864
  v_mfma_f32_32x32x16_bf16 v[64:79], a[68:71], a[84:87], v[64:79]
  ds_read_b128 a[56:59], v54 offset:16384
  ds_read_b64_tr_b16 a[40:41], v48 offset:40960
  ds_read_b64_tr_b16 a[42:43], v49 offset:40960
  ds_read_b128 a[60:63], v55 offset:16384
  ds_read_b64_tr_b16 a[44:45], v48 offset:45056
  ds_read_b64_tr_b16 a[46:47], v49 offset:45056
  s_add_u32 s24, s99, 0
  s_and_b32 s24, s24, 0x1ffff
  s_add_u32 s12, s98, 0
  s_add_u32 s8, s26, s24
  s_add_u32 s9, s26, s12
  s_add_u32 m0, s8, 0
  s_nop 0
  buffer_load_dwordx4 v18, s[32:35], s9 offen offset:0 nt lds
  buffer_load_dwordx4 v19, s[32:35], s9 offen offset:1024 nt lds
  s_add_u32 m0, s8, 16384
  s_nop 0
  buffer_load_dwordx4 v18, s[36:39], s9 offen offset:0 nt lds
  buffer_load_dwordx4 v19, s[36:39], s9 offen offset:1024 nt lds
  v_mfma_f32_32x32x16_bf16 v[64:79], a[72:75], a[88:91], v[64:79]
  v_mfma_f32_32x32x16_bf16 v[64:79], a[76:79], a[92:95], v[64:79]
  s_waitcnt vmcnt(8)
  s_waitcnt lgkmcnt(0)
  s_barrier
  v_mfma_f32_32x32x16_bf16 v[64:79], a[32:35], a[48:51], v[64:79]
  ds_read_b128 a[80:83], v52 offset:24576
  ds_read_b64_tr_b16 a[64:65], v48 offset:49152
  ds_read_b64_tr_b16 a[66:67], v49 offset:49152
  ds_read_b128 a[84:87], v53 offset:24576
  ds_read_b64_tr_b16 a[68:69], v48 offset:53248
  ds_read_b64_tr_b16 a[70:71], v49 offset:53248
  v_mfma_f32_32x32x16_bf16 v[64:79], a[36:39], a[52:55], v[64:79]
  ds_read_b128 a[88:91], v54 offset:24576
  ds_read_b64_tr_b16 a[72:73], v48 offset:57344
  ds_read_b64_tr_b16 a[74:75], v49 offset:57344
  ds_read_b128 a[92:95], v55 offset:24576
  ds_read_b64_tr_b16 a[76:77], v48 offset:61440
  ds_read_b64_tr_b16 a[78:79], v49 offset:61440
  v_mfma_f32_32x32x16_bf16 v[64:79], a[40:43], a[56:59], v[64:79]
  v_mfma_f32_32x32x16_bf16 v[64:79], a[44:47], a[60:63], v[64:79]
  s_waitcnt vmcnt(4)
  s_waitcnt lgkmcnt(0)
  s_barrier
  v_mfma_f32_32x32x16_bf16 v[64:79], a[64:67], a[80:83], v[64:79]
  ds_read_b128 a[48:51], v52 offset:0
  ds_read_b64_tr_b16 a[32:33], v48 offset:0
  ds_read_b64_tr_b16 a[34:35], v49 offset:0
  ds_read_b128 a[52:55], v53 offset:0
  ds_read_b64_tr_b16 a[36:37], v48 offset:4096
  ds_read_b64_tr_b16 a[38:39], v49 offset:4096
  v_mfma_f32_32x32x16_bf16 v[64:79], a[68:71], a[84:87], v[64:79]
  ds_read_b128 a[56:59], v54 offset:0
  ds_read_b64_tr_b16 a[40:41], v48 offset:8192
  ds_read_b64_tr_b16 a[42:43], v49 offset:8192
  ds_read_b128 a[60:63], v55 offset:0
  ds_read_b64_tr_b16 a[44:45], v48 offset:12288
  ds_read_b64_tr_b16 a[46:47], v49 offset:12288
  v_mfma_f32_32x32x16_bf16 v[64:79], a[72:75], a[88:91], v[64:79]
  v_mfma_f32_32x32x16_bf16 v[64:79], a[76:79], a[92:95], v[64:79]
  s_waitcnt lgkmcnt(0)
  v_mfma_f32_32x32x16_bf16 v[64:79], a[32:35], a[48:51], v[64:79]
  v_mfma_f32_32x32x16_bf16 v[64:79], a[36:39], a[52:55], v[64:79]
  v_mfma_f32_32x32x16_bf16 v[64:79], a[40:43], a[56:59], v[64:79]
  v_mfma_f32_32x32x16_bf16 v[64:79], a[44:47], a[60:63], v[64:79]
  s_lshl_b32 s9, s21, 2
  s_add_u32 s9, s9, s6
  s_lshl_b32 s9, s9, 14
  s_add_u32 s9, s9, 0x1600000
  s_add_u32 s9, s9, s26
  v_mov_b32 v24, 0xff7fffff
  v_mov_b32 v26, 0xff7fffff
  v_mov_b32 v25, 0
  v_mov_b32 v27, 0
  s_mov_b32 s11, s100
  s_mov_b32 s13, s99
  s_mov_b32 s0, 0
  s_mov_b32 s15, 1
  s_nop 3
  v_cvt_pk_bf16_f32 v40, v64, v65
  v_cvt_pk_bf16_f32 v41, v66, v67
  v_cvt_pk_bf16_f32 v42, v68, v69
  v_cvt_pk_bf16_f32 v43, v70, v71
  v_cvt_pk_bf16_f32 v44, v72, v73
  v_cvt_pk_bf16_f32 v45, v74, v75
  v_cvt_pk_bf16_f32 v46, v76, v77
  v_cvt_pk_bf16_f32 v47, v78, v79
  buffer_store_dwordx4 v[40:43], v31, s[56:59], s9 offen offset:0 sc1
  buffer_store_dwordx4 v[44:47], v31, s[56:59], s9 offen offset:1024 sc1
  s_add_u32 s24, s99, 32768
  s_and_b32 s24, s24, 0x1ffff
  s_add_u32 s12, s98, 16384
  s_add_u32 s8, s26, s24
  s_add_u32 s9, s26, s12
  s_add_u32 m0, s8, 0
  s_nop 0
  buffer_load_dwordx4 v18, s[32:35], s9 offen offset:0 nt lds
  buffer_load_dwordx4 v19, s[32:35], s9 offen offset:1024 nt lds
  s_add_u32 m0, s8, 16384
  s_nop 0
  buffer_load_dwordx4 v18, s[36:39], s9 offen offset:0 nt lds
  buffer_load_dwordx4 v19, s[36:39], s9 offen offset:1024 nt lds
  v_mov_b32 v64, 0
  v_mov_b32 v65, 0
  v_mov_b32 v66, 0
  v_mov_b32 v67, 0
  v_mov_b32 v68, 0
  v_mov_b32 v69, 0
  v_mov_b32 v70, 0
  v_mov_b32 v71, 0
  v_mov_b32 v72, 0
  v_mov_b32 v73, 0
  v_mov_b32 v74, 0
  v_mov_b32 v75, 0
  v_mov_b32 v76, 0
  v_mov_b32 v77, 0
  v_mov_b32 v78, 0
  v_mov_b32 v79, 0
  v_mov_b32 v80, 0
  v_mov_b32 v81, 0
  v_mov_b32 v82, 0
  v_mov_b32 v83, 0
  v_mov_b32 v84, 0
  v_mov_b32 v85, 0
  v_mov_b32 v86, 0
  v_mov_b32 v87, 0
  v_mov_b32 v88, 0
  v_mov_b32 v89, 0
  v_mov_b32 v90, 0
  v_mov_b32 v91, 0
  v_mov_b32 v92, 0
  v_mov_b32 v93, 0
  v_mov_b32 v94, 0
  v_mov_b32 v95, 0
  v_mov_b32 v96, 0
  v_mov_b32 v97, 0
  v_mov_b32 v98, 0
  v_mov_b32 v99, 0
  v_mov_b32 v100, 0
  v_mov_b32 v101, 0
  v_mov_b32 v102, 0
  v_mov_b32 v103, 0
  v_mov_b32 v104, 0
  v_mov_b32 v105, 0
  v_mov_b32 v106, 0
  v_mov_b32 v107, 0
  v_mov_b32 v108, 0
  v_mov_b32 v109, 0
  v_mov_b32 v110, 0
  v_mov_b32 v111, 0
  v_mov_b32 v112, 0
  v_mov_b32 v113, 0
  v_mov_b32 v114, 0
  v_mov_b32 v115, 0
  v_mov_b32 v116, 0
  v_mov_b32 v117, 0
  v_mov_b32 v118, 0
  v_mov_b32 v119, 0
  v_mov_b32 v120, 0
  v_mov_b32 v121, 0
  v_mov_b32 v122, 0
  v_mov_b32 v123, 0
  v_mov_b32 v124, 0
  v_mov_b32 v125, 0
  v_mov_b32 v126, 0
  v_mov_b32 v127, 0
  s_and_b32 s8, s6, 2
  s_lshl_b32 s10, s21, 2
  s_add_u32 s8, s8, s10
  s_lshl_b32 s8, s8, 1
  s_add_u32 s8, s8, s17
  s_lshl_b32 s25, s8, 13
  s_add_u32 s25, s25, 0x1600000
  s_add_u32 s14, s25, 4096
  s_add_u32 s8, s26, 131072
  v_add_u32 v20, s8, v31
  s_and_b32 s8, s17, 1
  s_lshl_b32 s8, s8, 13
  s_add_u32 s8, s8, 131072
  v_add_u32 v21, s8, v31
  s_waitcnt vmcnt(4)
  s_barrier
  ds_write_b128 v20, v[40:43] offset:0
  ds_write_b128 v20, v[44:47] offset:1024
  s_cmp_lg_u32 s3, 7
  s_cbranch_scc1 L_q_other
  v_cmp_gt_u32 vcc, 1, v34
  s_cbranch_vccz L_hs_skip
  s_lshl_b32 s9, s5, 2
  s_mov_b32 s23, 0
  s_mov_b32 exec_lo, 0x1
  s_mov_b32 exec_hi, 0
L_hs:
  buffer_load_dword v34, v23, s[60:63], s9 offen sc1
  s_add_u32 s23, s23, 1
  s_waitcnt vmcnt(0)
  v_cmp_gt_u32 vcc, 1, v34
  s_cbranch_vccz L_hs_ok
  s_cmp_gt_u32 s23, 32768
  s_cbranch_scc1 L_hs_ok
  s_sleep 2
  s_branch L_hs
L_hs_ok:
  s_mov_b64 exec, -1
L_hs_skip:
  s_lshl_b32 s9, s4, 2
  s_add_u32 s9, s9, s6
  s_add_u32 s9, s9, 64
  s_xor_b32 s10, s9, 1
  s_lshl_b32 s9, s9, 7
  s_add_u32 s9, s9, s28
  s_lshl_b32 s10, s10, 7
  s_add_u32 s10, s10, s28
  v_mov_b32 v22, 1
  s_mov_b64 exec, 1
  buffer_store_dword v22, v23, s[56:59], s9 offen sc1
  s_mov_b64 exec, -1
  s_mov_b32 s23, 0
  s_mov_b32 exec_lo, 0x1
  s_mov_b32 exec_hi, 0
L_pq:
  buffer_load_dword v34, v23, s[56:59], s10 offen sc1
  s_add_u32 s23, s23, 1
  s_waitcnt vmcnt(0)
  v_cmp_ne_u32 vcc, 1, v34
  s_cbranch_vccz L_pq_ok
  s_cmp_gt_u32 s23, 32768
  s_cbranch_scc1 L_pq_ok
  s_sleep 2
  s_branch L_pq
L_pq_ok:
  s_mov_b64 exec, -1
L_q_other:
  s_waitcnt lgkmcnt(0)
  s_barrier
  s_lshr_b32 s8, s17, 1
  s_and_b32 s9, s6, 1
  s_cmp_eq_u32 s8, s9
  s_cbranch_scc1 L_q_own
  buffer_load_dwordx4 a[0:3], v31, s[56:59], s25 offen offset:0 sc1
  buffer_load_dwordx4 a[4:7], v31, s[56:59], s25 offen offset:1024 sc1
  buffer_load_dwordx4 a[8:11], v31, s[56:59], s25 offen offset:2048 sc1
  buffer_load_dwordx4 a[12:15], v31, s[56:59], s25 offen offset:3072 sc1
  buffer_load_dwordx4 a[16:19], v31, s[56:59], s14 offen offset:0 sc1
  buffer_load_dwordx4 a[20:23], v31, s[56:59], s14 offen offset:1024 sc1
  buffer_load_dwordx4 a[24:27], v31, s[56:59], s14 offen offset:2048 sc1
  buffer_load_dwordx4 a[28:31], v31, s[56:59], s14 offen offset:3072 sc1
  s_branch L_q_got
L_q_own:
  ds_read_b128 a[0:3], v21 offset:0
  ds_read_b128 a[4:7], v21 offset:1024
  ds_read_b128 a[8:11], v21 offset:2048
  ds_read_b128 a[12:15], v21 offset:3072
  ds_read_b128 a[16:19], v21 offset:4096
  ds_read_b128 a[20:23], v21 offset:5120
  ds_read_b128 a[24:27], v21 offset:6144
  ds_read_b128 a[28:31], v21 offset:7168
L_q_got:
  s_waitcnt vmcnt(0) lgkmcnt(0)
  s_add_u32 s24, s99, 65536
  s_and_b32 s24, s24, 0x1ffff
  s_add_u32 s12, s98, 32768
  s_add_u32 s8, s26, s24
  s_add_u32 s9, s26, s12
  s_add_u32 m0, s8, 0
  s_nop 0
  buffer_load_dwordx4 v18, s[32:35], s9 offen offset:0 nt lds
  buffer_load_dwordx4 v19, s[32:35], s9 offen offset:1024 nt lds
  s_add_u32 m0, s8, 16384
  s_nop 0
  buffer_load_dwordx4 v18, s[36:39], s9 offen offset:0 nt lds
  buffer_load_dwordx4 v19, s[36:39], s9 offen offset:1024 nt lds
  s_add_u32 s24, s99, 98304
  s_and_b32 s24, s24, 0x1ffff
  s_add_u32 s12, s98, 49152
L_step:
  ds_read_b128 a[32:35], v2
  ds_read_b128 a[36:39], v3
  ds_read_b128 a[40:43], v4
  ds_read_b128 a[44:47], v5
  ds_read_b128 a[48:51], v6
  ds_read_b128 a[52:55], v7
  ds_read_b128 a[56:59], v8
  ds_read_b128 a[60:63], v9
  s_mov_b32 s31, s0
  s_mov_b32 s0, 0
  s_cmp_lg_u32 s3, s5
  s_cbranch_scc1 L_nowarm
  s_sub_u32 s9, s11, 2
  s_cmp_ge_u32 s9, 3
  s_cbranch_scc1 L_nowarm
  s_add_u32 s9, s9, 1
  s_mul_i32 s9, s9, 147456
  s_add_u32 s9, s9, s20
  s_mov_b32 m0, 147456
  s_add_u32 s8, s9, 0
  buffer_load_dwordx4 v35, s[48:51], s8 offen lds
  s_mov_b32 m0, 148480
  s_add_u32 s8, s9, 4608
  buffer_load_dwordx4 v36, s[48:51], s8 offen lds
  s_mov_b32 m0, 149504
  s_add_u32 s8, s9, 9216
  buffer_load_dwordx4 v37, s[48:51], s8 offen lds
  s_mov_b32 m0, 150528
  s_add_u32 s8, s9, 13824
  buffer_load_dwordx4 v38, s[48:51], s8 offen lds
  s_mov_b32 s0, 1
  s_add_u32 s31, s31, 1
L_nowarm:
  s_cmp_ge_i32 s11, 13
  s_cbranch_scc1 L_dma_wo
  s_add_u32 s8, s26, s24
  s_add_u32 s9, s26, s12
  s_add_u32 m0, s8, 0
  s_nop 0
  buffer_load_dwordx4 v18, s[32:35], s9 offen offset:0 nt lds
  buffer_load_dwordx4 v19, s[32:35], s9 offen offset:1024 nt lds
  s_add_u32 m0, s8, 16384
  s_nop 0
  buffer_load_dwordx4 v18, s[36:39], s9 offen offset:0 nt lds
  buffer_load_dwordx4 v19, s[36:39], s9 offen offset:1024 nt lds
  s_add_u32 s12, s12, 16384
  s_branch L_dma_done
L_dma_wo:
  s_cmp_lg_u32 s11, 13
  s_cbranch_scc1 L_dma_wo4
  s_add_u32 s10, s27, 0
  s_add_u32 m0, s10, 0
  s_add_u32 s8, s20, 0
  buffer_load_dwordx4 v35, s[48:51], s8 offen lds
  s_add_u32 m0, s10, 1024
  s_add_u32 s8, s20, 4608
  buffer_load_dwordx4 v36, s[48:51], s8 offen lds
  s_add_u32 m0, s10, 2048
  s_add_u32 s8, s20, 9216
  buffer_load_dwordx4 v37, s[48:51], s8 offen lds
  s_add_u32 m0, s10, 3072
  s_add_u32 s8, s20, 13824
  buffer_load_dwordx4 v38, s[48:51], s8 offen lds
  s_branch L_dma_done
L_dma_wo4:
  s_cmp_lg_u32 s11, 14
  s_cbranch_scc1 L_dma_done
  s_add_u32 m0, s29, 131072
  s_add_u32 s8, s30, 0
  buffer_load_dwordx4 v32, s[48:51], s8 offen lds
  s_add_u32 m0, s29, 135168
  s_add_u32 s8, s30, 147456
  buffer_load_dwordx4 v32, s[48:51], s8 offen lds
L_dma_done:
  s_waitcnt lgkmcnt(0)
  v_mfma_f32_32x32x16_bf16 v[48:63], a[32:35], a[0:3], 0
  ds_read_b64_tr_b16 a[64:65], v10 offset:16384
  ds_read_b64_tr_b16 a[66:67], v11 offset:16384
  v_mfma_f32_32x32x16_bf16 v[48:63], a[36:39], a[4:7], v[48:63]
  ds_read_b64_tr_b16 a[72:73], v12 offset:16384
  ds_read_b64_tr_b16 a[74:75], v13 offset:16384
  v_mfma_f32_32x32x16_bf16 v[48:63], a[40:43], a[8:11], v[48:63]
  ds_read_b64_tr_b16 a[80:81], v14 offset:16384
  ds_read_b64_tr_b16 a[82:83], v15 offset:16384
  v_mfma_f32_32x32x16_bf16 v[48:63], a[44:47], a[12:15], v[48:63]
  ds_read_b64_tr_b16 a[88:89], v16 offset:16384
  ds_read_b64_tr_b16 a[90:91], v17 offset:16384
  v_mfma_f32_32x32x16_bf16 v[48:63], a[48:51], a[16:19], v[48:63]
  ds_read_b64_tr_b16 a[68:69], v10 offset:20480
  ds_read_b64_tr_b16 a[70:71], v11 offset:20480
  v_mfma_f32_32x32x16_bf16 v[48:63], a[52:55], a[20:23], v[48:63]
  ds_read_b64_tr_b16 a[76:77], v12 offset:20480
  ds_read_b64_tr_b16 a[78:79], v13 offset:20480
  v_mfma_f32_32x32x16_bf16 v[48:63], a[56:59], a[24:27], v[48:63]
  ds_read_b64_tr_b16 a[84:85], v14 offset:20480
  ds_read_b64_tr_b16 a[86:87], v15 offset:20480
  v_mfma_f32_32x32x16_bf16 v[48:63], a[60:63], a[28:31], v[48:63]
  ds_read_b64_tr_b16 a[92:93], v16 offset:20480
  ds_read_b64_tr_b16 a[94:95], v17 offset:20480
  s_add_u32 s11, s11, 1
  s_mov_b32 s24, s13
  s_add_u32 s13, s13, 32768
  s_and_b32 s13, s13, 0x1ffff
  s_sub_u32 s14, s13, s24
  v_add_u32 v2, s14, v2
  v_add_u32 v3, s14, v3
  v_add_u32 v4, s14, v4
  v_add_u32 v5, s14, v5
  v_add_u32 v6, s14, v6
  v_add_u32 v7, s14, v7
  v_add_u32 v8, s14, v8
  v_add_u32 v9, s14, v9
  v_add_u32 v10, s14, v10
  v_add_u32 v11, s14, v11
  v_add_u32 v12, s14, v12
  v_add_u32 v13, s14, v13
  v_add_u32 v14, s14, v14
  v_add_u32 v15, s14, v15
  v_add_u32 v16, s14, v16
  v_add_u32 v17, s14, v17
  v_max3_f32 v29, v48, v49, v50
  v_max3_f32 v30, v51, v52, v53
  v_max3_f32 v29, v29, v54, v55
  v_max3_f32 v30, v30, v56, v57
  v_max3_f32 v29, v29, v58, v59
  v_max3_f32 v30, v30, v60, v61
  v_max3_f32 v29, v29, v62, v63
  v_max_f32 v29, v29, v30
  v_mov_b32 v30, v29
  s_nop 1
  v_permlane32_swap_b32 v29, v30
  v_max_f32 v29, v29, v30
  v_cmp_gt_f32 vcc, v29, v26
  s_cbranch_vccnz L_rs
L_rs_ret:
  v_fma_f32 v48, v48, s7, -v25
  v_fma_f32 v49, v49, s7, -v25
  v_exp_f32 v48, v48
  v_fma_f32 v50, v50, s7, -v25
  v_exp_f32 v49, v49
  v_fma_f32 v51, v51, s7, -v25
  v_add_f32 v27, v27, v48
  v_exp_f32 v50, v50
  v_fma_f32 v52, v52, s7, -v25
  v_add_f32 v27, v27, v49
  v_cvt_pk_bf16_f32 v40, v48, v49
  v_exp_f32 v51, v51
  v_fma_f32 v53, v53, s7, -v25
  v_add_f32 v27, v27, v50
  v_exp_f32 v52, v52
  v_fma_f32 v54, v54, s7, -v25
  v_add_f32 v27, v27, v51
  v_cvt_pk_bf16_f32 v41, v50, v51
  v_exp_f32 v53, v53
  v_fma_f32 v55, v55, s7, -v25
  v_add_f32 v27, v27, v52
  v_exp_f32 v54, v54
  v_fma_f32 v56, v56, s7, -v25
  v_add_f32 v27, v27, v53
  v_cvt_pk_bf16_f32 v42, v52, v53
  v_exp_f32 v55, v55
  v_fma_f32 v57, v57, s7, -v25
  v_add_f32 v27, v27, v54
  v_exp_f32 v56, v56
  v_fma_f32 v58, v58, s7, -v25
  v_add_f32 v27, v27, v55
  v_cvt_pk_bf16_f32 v43, v54, v55
  s_waitcnt lgkmcnt(0)
  v_exp_f32 v57, v57
  v_fma_f32 v59, v59, s7, -v25
  v_mfma_f32_32x32x16_bf16 v[64:79], a[64:67], v[40:43], v[64:79]
  v_add_f32 v27, v27, v56
  v_exp_f32 v58, v58
  v_fma_f32 v60, v60, s7, -v25
  v_add_f32 v27, v27, v57
  v_cvt_pk_bf16_f32 v44, v56, v57
  v_mfma_f32_32x32x16_bf16 v[80:95], a[72:75], v[40:43], v[80:95]
  v_exp_f32 v59, v59
  v_fma_f32 v61, v61, s7, -v25
  v_add_f32 v27, v27, v58
  v_exp_f32 v60, v60
  v_fma_f32 v62, v62, s7, -v25
  v_add_f32 v27, v27, v59
  v_mfma_f32_32x32x16_bf16 v[96:111], a[80:83], v[40:43], v[96:111]
  v_cvt_pk_bf16_f32 v45, v58, v59
  v_exp_f32 v61, v61
  v_fma_f32 v63, v63, s7, -v25
  v_add_f32 v27, v27, v60
  v_exp_f32 v62, v62
  v_add_f32 v27, v27, v61
  v_mfma_f32_32x32x16_bf16 v[112:127], a[88:91], v[40:43], v[112:127]
  v_cvt_pk_bf16_f32 v46, v60, v61
  v_exp_f32 v63, v63
  v_add_f32 v27, v27, v62
  s_nop 0
  v_add_f32 v27, v27, v63
  v_cvt_pk_bf16_f32 v47, v62, v63
  s_mov_b32 s15, 0
  s_cmp_eq_u32 s11, 16
  v_mfma_f32_32x32x16_bf16 v[64:79], a[68:71], v[44:47], v[64:79]
  v_mfma_f32_32x32x16_bf16 v[80:95], a[76:79], v[44:47], v[80:95]
  v_mfma_f32_32x32x16_bf16 v[96:111], a[84:87], v[44:47], v[96:111]
  v_mfma_f32_32x32x16_bf16 v[112:127], a[92:95], v[44:47], v[112:127]
  s_cbranch_scc1 L_loop_end
  s_cmp_eq_u32 s11, 15
  s_cbranch_scc1 L_ctl15
  s_cmp_lg_u32 s31, 0
  s_cbranch_scc1 L_ctlw
  s_waitcnt vmcnt(8)
  s_barrier
  s_branch L_step
L_ctlw:
  s_cmp_eq_u32 s31, 2
  s_cbranch_scc1 L_ctlw2
  s_waitcnt vmcnt(12)
  s_barrier
  s_branch L_step
L_ctlw2:
  s_waitcnt vmcnt(16)
  s_barrier
  s_branch L_step
L_ctl15:
  s_waitcnt vmcnt(6)
  s_barrier
  s_branch L_step
L_rs:
  v_max_f32 v29, v29, v24
  v_sub_f32 v28, v24, v29
  v_mul_f32 v28, s7, v28
  v_exp_f32 v28, v28
  v_mov_b32 v24, v29
  v_mul_f32 v25, s7, v29
  v_add_f32 v26, 0x427af233, v29
  v_mul_f32 v27, v27, v28
  s_cmp_eq_u32 s15, 1
  s_cbranch_scc1 L_rs_ret
  v_mul_f32 v64, v64, v28
  v_mul_f32 v65, v65, v28
  v_mul_f32 v66, v66, v28
  v_mul_f32 v67, v67, v28
  v_mul_f32 v68, v68, v28
  v_mul_f32 v69, v69, v28
  v_mul_f32 v70, v70, v28
  v_mul_f32 v71, v71, v28
  v_mul_f32 v72, v72, v28
  v_mul_f32 v73, v73, v28
  v_mul_f32 v74, v74, v28
  v_mul_f32 v75, v75, v28
  v_mul_f32 v76, v76, v28
  v_mul_f32 v77, v77, v28
  v_mul_f32 v78, v78, v28
  v_mul_f32 v79, v79, v28
  v_mul_f32 v80, v80, v28
  v_mul_f32 v81, v81, v28
  v_mul_f32 v82, v82, v28
  v_mul_f32 v83, v83, v28
  v_mul_f32 v84, v84, v28
  v_mul_f32 v85, v85, v28
  v_mul_f32 v86, v86, v28
  v_mul_f32 v87, v87, v28
  v_mul_f32 v88, v88, v28
  v_mul_f32 v89, v89, v28
  v_mul_f32 v90, v90, v28
  v_mul_f32 v91, v91, v28
  v_mul_f32 v92, v92, v28
  v_mul_f32 v93, v93, v28
  v_mul_f32 v94, v94, v28
  v_mul_f32 v95, v95, v28
  v_mul_f32 v96, v96, v28
  v_mul_f32 v97, v97, v28
  v_mul_f32 v98, v98, v28
  v_mul_f32 v99, v99, v28
  v_mul_f32 v100, v100, v28
  v_mul_f32 v101, v101, v28
  v_mul_f32 v102, v102, v28
  v_mul_f32 v103, v103, v28
  v_mul_f32 v104, v104, v28
  v_mul_f32 v105, v105, v28
  v_mul_f32 v106, v106, v28
  v_mul_f32 v107, v107, v28
  v_mul_f32 v108, v108, v28
  v_mul_f32 v109, v109, v28
  v_mul_f32 v110, v110, v28
  v_mul_f32 v111, v111, v28
  v_mul_f32 v112, v112, v28
  v_mul_f32 v113, v113, v28
  v_mul_f32 v114, v114, v28
  v_mul_f32 v115, v115, v28
  v_mul_f32 v116, v116, v28
  v_mul_f32 v117, v117, v28
  v_mul_f32 v118, v118, v28
  v_mul_f32 v119, v119, v28
  v_mul_f32 v120, v120, v28
  v_mul_f32 v121, v121, v28
  v_mul_f32 v122, v122, v28
  v_mul_f32 v123, v123, v28
  v_mul_f32 v124, v124, v28
  v_mul_f32 v125, v125, v28
  v_mul_f32 v126, v126, v28
  v_mul_f32 v127, v127, v28
  s_branch L_rs_ret
L_loop_end:
  s_nop 3
  v_mov_b32 v29, v27
  s_nop 1
  v_permlane32_swap_b32 v29, v27
  v_add_f32 v26, v29, v27
  v_mov_b32 v40, v25
  v_mov_b32 v41, v26
  s_lshl_b32 s8, s26, 2
  s_add_u32 s8, s8, 32768
  v_add_u32 v20, s8, v31
  s_xor_b32 s9, s3, 4
  s_lshl_b32 s10, s9, 13
  s_add_u32 s10, s10, 32768
  v_add_u32 v21, s10, v31
  s_lshl_b32 s8, s3, 9
  s_add_u32 s8, s8, 147456
  v_lshlrev_b32 v22, 3, v1
  v_add_u32 v29, s8, v22
  s_lshl_b32 s9, s9, 9
  s_add_u32 s9, s9, 147456
  v_add_u32 v30, s9, v22
  ds_write_b64 v29, v[40:41]
  ds_write_b128 v20, v[96:99] offset:0
  ds_write_b128 v20, v[100:103] offset:1024
  ds_write_b128 v20, v[104:107] offset:2048
  ds_write_b128 v20, v[108:111] offset:3072
  ds_write_b128 v20, v[112:115] offset:4096
  ds_write_b128 v20, v[116:119] offset:5120
  ds_write_b128 v20, v[120:123] offset:6144
  ds_write_b128 v20, v[124:127] offset:7168
  s_waitcnt lgkmcnt(0)
  s_barrier
  ds_read_b64 v[42:43], v30
  ds_read_b128 v[96:99], v21 offset:0
  ds_read_b128 v[100:103], v21 offset:1024
  ds_read_b128 v[104:107], v21 offset:2048
  ds_read_b128 v[108:111], v21 offset:3072
  ds_read_b128 v[112:115], v21 offset:4096
  ds_read_b128 v[116:119], v21 offset:5120
  ds_read_b128 v[120:123], v21 offset:6144
  ds_read_b128 v[124:127], v21 offset:7168
  s_waitcnt lgkmcnt(8)
  v_max_f32 v44, v40, v42
  v_sub_f32 v45, v40, v44
  v_sub_f32 v46, v42, v44
  v_exp_f32 v45, v45
  v_exp_f32 v46, v46
  s_nop 0
  v_mul_f32 v47, v45, v41
  v_fma_f32 v47, v46, v43, v47
  v_rcp_f32 v28, v47
  v_log_f32 v29, v47
  s_lshl_b32 s9, s21, 2
  s_add_u32 s9, s9, s6
  s_lshl_b32 s9, s9, 2
  s_add_u32 s9, s9, s17
  s_lshl_b32 s9, s9, 1
  s_add_u32 s9, s9, s18
  s_lshl_b32 s9, s9, 12
  v_mul_f32 v45, v45, v28
  v_mul_f32 v46, v46, v28
  v_add_f32 v29, v29, v44
  s_lshr_b32 s8, s6, 1
  s_lshl_b32 s8, s8, 2
  s_add_u32 s8, s8, s17
  s_lshl_b32 s25, s21, 3
  s_add_u32 s8, s8, s25
  s_lshl_b32 s8, s8, 8
  s_and_b32 s25, s6, 1
  s_lshl_b32 s25, s25, 7
  s_add_u32 s8, s8, s25
  s_add_u32 s8, s8, 0x1400000
  v_and_b32 v20, 31, v1
  v_lshlrev_b32 v20, 2, v20
  buffer_store_dword v29, v20, s[56:59], s8 offen sc1
  v_mul_f32 v64, v64, v45
  v_mul_f32 v65, v65, v45
  v_mul_f32 v66, v66, v45
  v_mul_f32 v67, v67, v45
  v_mul_f32 v68, v68, v45
  v_mul_f32 v69, v69, v45
  v_mul_f32 v70, v70, v45
  v_mul_f32 v71, v71, v45
  s_waitcnt lgkmcnt(6)
  v_fma_f32 v64, v96, v46, v64
  v_fma_f32 v65, v97, v46, v65
  v_fma_f32 v66, v98, v46, v66
  v_fma_f32 v67, v99, v46, v67
  v_fma_f32 v68, v100, v46, v68
  v_fma_f32 v69, v101, v46, v69
  v_fma_f32 v70, v102, v46, v70
  v_fma_f32 v71, v103, v46, v71
  v_cvt_pk_bf16_f32 v48, v64, v65
  v_cvt_pk_bf16_f32 v49, v66, v67
  v_cvt_pk_bf16_f32 v50, v68, v69
  v_cvt_pk_bf16_f32 v51, v70, v71
  buffer_store_dwordx4 v[48:51], v31, s[56:59], s9 offen offset:0 sc1
  v_mul_f32 v72, v72, v45
  v_mul_f32 v73, v73, v45
  v_mul_f32 v74, v74, v45
  v_mul_f32 v75, v75, v45
  v_mul_f32 v76, v76, v45
  v_mul_f32 v77, v77, v45
  v_mul_f32 v78, v78, v45
  v_mul_f32 v79, v79, v45
  s_waitcnt lgkmcnt(4)
  v_fma_f32 v72, v104, v46, v72
  v_fma_f32 v73, v105, v46, v73
  v_fma_f32 v74, v106, v46, v74
  v_fma_f32 v75, v107, v46, v75
  v_fma_f32 v76, v108, v46, v76
  v_fma_f32 v77, v109, v46, v77
  v_fma_f32 v78, v110, v46, v78
  v_fma_f32 v79, v111, v46, v79
  v_cvt_pk_bf16_f32 v52, v72, v73
  v_cvt_pk_bf16_f32 v53, v74, v75
  v_cvt_pk_bf16_f32 v54, v76, v77
  v_cvt_pk_bf16_f32 v55, v78, v79
  buffer_store_dwordx4 v[52:55], v31, s[56:59], s9 offen offset:1024 sc1
  v_mul_f32 v80, v80, v45
  v_mul_f32 v81, v81, v45
  v_mul_f32 v82, v82, v45
  v_mul_f32 v83, v83, v45
  v_mul_f32 v84, v84, v45
  v_mul_f32 v85, v85, v45
  v_mul_f32 v86, v86, v45
  v_mul_f32 v87, v87, v45
  s_waitcnt lgkmcnt(2)
  v_fma_f32 v80, v112, v46, v80
  v_fma_f32 v81, v113, v46, v81
  v_fma_f32 v82, v114, v46, v82
  v_fma_f32 v83, v115, v46, v83
  v_fma_f32 v84, v116, v46, v84
  v_fma_f32 v85, v117, v46, v85
  v_fma_f32 v86, v118, v46, v86
  v_fma_f32 v87, v119, v46, v87
  v_cvt_pk_bf16_f32 v56, v80, v81
  v_cvt_pk_bf16_f32 v57, v82, v83
  v_cvt_pk_bf16_f32 v58, v84, v85
  v_cvt_pk_bf16_f32 v59, v86, v87
  buffer_store_dwordx4 v[56:59], v31, s[56:59], s9 offen offset:2048 sc1
  v_mul_f32 v88, v88, v45
  v_mul_f32 v89, v89, v45
  v_mul_f32 v90, v90, v45
  v_mul_f32 v91, v91, v45
  v_mul_f32 v92, v92, v45
  v_mul_f32 v93, v93, v45
  v_mul_f32 v94, v94, v45
  v_mul_f32 v95, v95, v45
  s_waitcnt lgkmcnt(0)
  v_fma_f32 v88, v120, v46, v88
  v_fma_f32 v89, v121, v46, v89
  v_fma_f32 v90, v122, v46, v90
  v_fma_f32 v91, v123, v46, v91
  v_fma_f32 v92, v124, v46, v92
  v_fma_f32 v93, v125, v46, v93
  v_fma_f32 v94, v126, v46, v94
  v_fma_f32 v95, v127, v46, v95
  v_cvt_pk_bf16_f32 v60, v88, v89
  v_cvt_pk_bf16_f32 v61, v90, v91
  v_cvt_pk_bf16_f32 v62, v92, v93
  v_cvt_pk_bf16_f32 v63, v94, v95
  buffer_store_dwordx4 v[60:63], v31, s[56:59], s9 offen offset:3072 sc1
  s_add_u32 s10, s27, 98304
  s_add_u32 m0, s10, 0
  s_add_u32 s8, s20, 442368
  buffer_load_dwordx4 v35, s[48:51], s8 offen lds
  s_add_u32 m0, s10, 1024
  s_add_u32 s8, s20, 446976
  buffer_load_dwordx4 v36, s[48:51], s8 offen lds
  s_add_u32 m0, s10, 2048
  s_add_u32 s8, s20, 451584
  buffer_load_dwordx4 v37, s[48:51], s8 offen lds
  s_add_u32 m0, s10, 3072
  s_add_u32 s8, s20, 456192
  buffer_load_dwordx4 v38, s[48:51], s8 offen lds
  s_lshl_b32 s11, s4, 9
  s_add_u32 s11, s11, s28
  s_lshl_b32 s9, s6, 7
  s_add_u32 s9, s9, s11
  v_mov_b32 v20, 1
  v_lshlrev_b32 v21, 7, v1
  s_waitcnt vmcnt(4)
  s_barrier
  s_cmp_lg_u32 s3, 0
  s_cbranch_scc1 L_h1_other
  s_mov_b64 exec, 1
  buffer_store_dword v20, v23, s[56:59], s9 offen sc1
  s_mov_b64 exec, -1
L_h1_other:
  s_add_u32 s10, s27, 32768
  s_add_u32 m0, s10, 0
  s_add_u32 s8, s20, 147456
  buffer_load_dwordx4 v35, s[48:51], s8 offen lds
  s_add_u32 m0, s10, 1024
  s_add_u32 s8, s20, 152064
  buffer_load_dwordx4 v36, s[48:51], s8 offen lds
  s_add_u32 m0, s10, 2048
  s_add_u32 s8, s20, 156672
  buffer_load_dwordx4 v37, s[48:51], s8 offen lds
  s_add_u32 m0, s10, 3072
  s_add_u32 s8, s20, 161280
  buffer_load_dwordx4 v38, s[48:51], s8 offen lds
  s_add_u32 s10, s27, 65536
  s_add_u32 m0, s10, 0
  s_add_u32 s8, s20, 294912
  buffer_load_dwordx4 v35, s[48:51], s8 offen lds
  s_add_u32 m0, s10, 1024
  s_add_u32 s8, s20, 299520
  buffer_load_dwordx4 v36, s[48:51], s8 offen lds
  s_add_u32 m0, s10, 2048
  s_add_u32 s8, s20, 304128
  buffer_load_dwordx4 v37, s[48:51], s8 offen lds
  s_add_u32 m0, s10, 3072
  s_add_u32 s8, s20, 308736
  buffer_load_dwordx4 v38, s[48:51], s8 offen lds
  s_cmp_lg_u32 s3, 0
  s_cbranch_scc1 L_h1_other2
  s_mov_b32 s23, 0
  s_lshl_b32 s8, 1, s6
  s_andn2_b32 exec_lo, 0xf, s8
  s_mov_b32 exec_hi, 0
L_p1:
  buffer_load_dword v34, v21, s[56:59], s11 offen sc1
  s_add_u32 s23, s23, 1
  s_waitcnt vmcnt(0)
  v_cmp_ne_u32 vcc, 1, v34
  s_cbranch_vccz L_p1_ok
  s_cmp_gt_u32 s23, 32768
  s_cbranch_scc1 L_p1_ok
  s_sleep 2
  s_branch L_p1
L_p1_ok:
  s_mov_b64 exec, -1
L_h1_other2:
  s_sub_u32 s8, s17, s18
  s_lshl_b32 s8, s8, 13
  s_sub_u32 s8, s8, s13
  s_lshl_b32 s9, s17, 4
  v_add_u32 v10, s8, v10
  v_xor_b32 v10, s9, v10
  v_add_u32 v2, 0x10000, v10
  v_add_u32 v11, s8, v11
  v_xor_b32 v11, s9, v11
  v_add_u32 v3, 0x10000, v11
  v_add_u32 v12, s8, v12
  v_xor_b32 v12, s9, v12
  v_add_u32 v4, 0x10000, v12
  v_add_u32 v13, s8, v13
  v_xor_b32 v13, s9, v13
  v_add_u32 v5, 0x10000, v13
  v_add_u32 v14, s8, v14
  v_xor_b32 v14, s9, v14
  v_add_u32 v6, 0x10000, v14
  v_add_u32 v15, s8, v15
  v_xor_b32 v15, s9, v15
  v_add_u32 v7, 0x10000, v15
  v_add_u32 v16, s8, v16
  v_xor_b32 v16, s9, v16
  v_add_u32 v8, 0x10000, v16
  v_add_u32 v17, s8, v17
  v_xor_b32 v17, s9, v17
  v_add_u32 v9, 0x10000, v17
  v_lshlrev_b32 v20, 2, v1
  s_barrier
  s_lshl_b32 s8, s21, 11
  s_lshl_b32 s9, s18, 8
  s_add_u32 s8, s8, s9
  s_add_u32 s8, s8, 0x1400000
  buffer_load_dword v128, v20, s[56:59], s8 offen offset:0 sc1
  buffer_load_dword v129, v20, s[56:59], s8 offen offset:512 sc1
  buffer_load_dword v130, v20, s[56:59], s8 offen offset:1024 sc1
  buffer_load_dword v131, v20, s[56:59], s8 offen offset:1536 sc1
  s_lshl_b32 s9, s21, 17
  s_lshl_b32 s10, s17, 11
  s_add_u32 s9, s9, s10
  s_lshl_b32 s10, s18, 13
  s_add_u32 s9, s9, s10
  s_mov_b32 s12, s9
  s_add_u32 s24, s12, 0
  buffer_load_dwordx4 v[64:67], v31, s[56:59], s24 offen offset:0 sc1
  buffer_load_dwordx4 v[68:71], v31, s[56:59], s24 offen offset:1024 sc1
  s_add_u32 s24, s12, 32768
  buffer_load_dwordx4 v[72:75], v31, s[56:59], s24 offen offset:0 sc1
  buffer_load_dwordx4 v[76:79], v31, s[56:59], s24 offen offset:1024 sc1
  s_waitcnt vmcnt(8)
  s_barrier
  s_add_u32 s24, s12, 16384
  buffer_load_dwordx4 v[80:83], v31, s[56:59], s24 offen offset:0 sc1
  buffer_load_dwordx4 v[84:87], v31, s[56:59], s24 offen offset:1024 sc1
  s_add_u32 s24, s12, 49152
  buffer_load_dwordx4 v[88:91], v31, s[56:59], s24 offen offset:0 sc1
  buffer_load_dwordx4 v[92:95], v31, s[56:59], s24 offen offset:1024 sc1
  ds_read_b64_tr_b16 a[80:81], v10 offset:0
  ds_read_b64_tr_b16 a[82:83], v11 offset:0
  ds_read_b64_tr_b16 a[84:85], v10 offset:4096
  ds_read_b64_tr_b16 a[86:87], v11 offset:4096
  ds_read_b64_tr_b16 a[88:89], v12 offset:0
  ds_read_b64_tr_b16 a[90:91], v13 offset:0
  ds_read_b64_tr_b16 a[92:93], v12 offset:4096
  ds_read_b64_tr_b16 a[94:95], v13 offset:4096
  ds_read_b64_tr_b16 a[96:97], v14 offset:0
  ds_read_b64_tr_b16 a[98:99], v15 offset:0
  ds_read_b64_tr_b16 a[100:101], v14 offset:4096
  ds_read_b64_tr_b16 a[102:103], v15 offset:4096
  ds_read_b64_tr_b16 a[104:105], v16 offset:0
  ds_read_b64_tr_b16 a[106:107], v17 offset:0
  s_mul_i32 s8, s18, 49152
  s_xor_b32 s9, s17, 1
  s_mul_i32 s9, s9, 12288
  s_add_u32 s9, s9, s8
  s_add_u32 s9, s9, 0
  v_add_u32 v140, s9, v31
  s_xor_b32 s9, s17, 2
  s_mul_i32 s9, s9, 12288
  s_add_u32 s9, s9, s8
  s_add_u32 s9, s9, 4096
  v_add_u32 v141, s9, v31
  s_xor_b32 s9, s17, 3
  s_mul_i32 s9, s9, 12288
  s_add_u32 s9, s9, s8
  s_add_u32 s9, s9, 8192
  v_add_u32 v142, s9, v31
  s_mul_i32 s9, s17, 12288
  s_add_u32 s9, s9, s8
  v_add_u32 v143, s9, v31
  s_lshl_b32 s8, s18, 13
  s_add_u32 s8, s8, 147456
  s_lshl_b32 s9, s17, 10
  s_add_u32 s9, s9, s8
  v_add_u32 v21, s9, v31
  s_and_b32 s9, s17, 1
  s_lshl_b32 s9, s9, 12
  s_add_u32 s9, s9, s8
  v_add_u32 v22, s9, v31
  s_waitcnt vmcnt(8)
  v_mov_b32 v136, v128
  v_mov_b32 v137, v129
  v_mov_b32 v138, v130
  v_mov_b32 v139, v131
  s_nop 1
  v_permlane32_swap_b32 v128, v136
  v_permlane32_swap_b32 v129, v137
  v_permlane32_swap_b32 v130, v138
  v_permlane32_swap_b32 v131, v139
  v_sub_f32 v136, v136, v128
  v_sub_f32 v137, v137, v129
  v_sub_f32 v138, v138, v130
  v_sub_f32 v139, v139, v131
  v_exp_f32 v136, v136
  v_exp_f32 v137, v137
  v_exp_f32 v138, v138
  v_exp_f32 v139, v139
  v_add_f32 v136, 1.0, v136
  v_add_f32 v137, 1.0, v137
  v_add_f32 v138, 1.0, v138
  v_add_f32 v139, 1.0, v139
  v_rcp_f32 v132, v136
  v_rcp_f32 v133, v137
  v_rcp_f32 v134, v138
  v_rcp_f32 v135, v139
  v_sub_f32 v136, 1.0, v132
  v_sub_f32 v137, 1.0, v133
  v_sub_f32 v138, 1.0, v134
  v_sub_f32 v139, 1.0, v135
  s_mov_b32 s25, 0xffff0000
  s_add_u32 s24, s12, 65536
  buffer_load_dwordx4 v[96:99], v31, s[56:59], s24 offen offset:0 sc1
  buffer_load_dwordx4 v[100:103], v31, s[56:59], s24 offen offset:1024 sc1
  s_add_u32 s24, s12, 98304
  buffer_load_dwordx4 v[104:107], v31, s[56:59], s24 offen offset:0 sc1
  buffer_load_dwordx4 v[108:111], v31, s[56:59], s24 offen offset:1024 sc1
  s_waitcnt vmcnt(8)
  v_lshlrev_b32 v40, 16, v64
  v_and_b32 v41, s25, v64
  v_lshlrev_b32 v42, 16, v72
  v_and_b32 v43, s25, v72
  v_mul_f32 v40, v40, v132
  v_mul_f32 v41, v41, v132
  v_fma_f32 v40, v42, v136, v40
  v_fma_f32 v41, v43, v136, v41
  v_cvt_pk_bf16_f32 v64, v40, v41
  v_lshlrev_b32 v44, 16, v65
  v_and_b32 v45, s25, v65
  v_lshlrev_b32 v46, 16, v73
  v_and_b32 v47, s25, v73
  v_mul_f32 v44, v44, v132
  v_mul_f32 v45, v45, v132
  v_fma_f32 v44, v46, v136, v44
  v_fma_f32 v45, v47, v136, v45
  v_cvt_pk_bf16_f32 v65, v44, v45
  v_lshlrev_b32 v48, 16, v66
  v_and_b32 v49, s25, v66
  v_lshlrev_b32 v50, 16, v74
  v_and_b32 v51, s25, v74
  v_mul_f32 v48, v48, v132
  v_mul_f32 v49, v49, v132
  v_fma_f32 v48, v50, v136, v48
  v_fma_f32 v49, v51, v136, v49
  v_cvt_pk_bf16_f32 v66, v48, v49
  v_lshlrev_b32 v52, 16, v67
  v_and_b32 v53, s25, v67
  v_lshlrev_b32 v54, 16, v75
  v_and_b32 v55, s25, v75
  v_mul_f32 v52, v52, v132
  v_mul_f32 v53, v53, v132
  v_fma_f32 v52, v54, v136, v52
  v_fma_f32 v53, v55, v136, v53
  v_cvt_pk_bf16_f32 v67, v52, v53
  v_lshlrev_b32 v40, 16, v68
  v_and_b32 v41, s25, v68
  v_lshlrev_b32 v42, 16, v76
  v_and_b32 v43, s25, v76
  v_mul_f32 v40, v40, v132
  v_mul_f32 v41, v41, v132
  v_fma_f32 v40, v42, v136, v40
  v_fma_f32 v41, v43, v136, v41
  v_cvt_pk_bf16_f32 v68, v40, v41
  v_lshlrev_b32 v44, 16, v69
  v_and_b32 v45, s25, v69
  v_lshlrev_b32 v46, 16, v77
  v_and_b32 v47, s25, v77
  v_mul_f32 v44, v44, v132
  v_mul_f32 v45, v45, v132
  v_fma_f32 v44, v46, v136, v44
  v_fma_f32 v45, v47, v136, v45
  v_cvt_pk_bf16_f32 v69, v44, v45
  v_lshlrev_b32 v48, 16, v70
  v_and_b32 v49, s25, v70
  v_lshlrev_b32 v50, 16, v78
  v_and_b32 v51, s25, v78
  v_mul_f32 v48, v48, v132
  v_mul_f32 v49, v49, v132
  v_fma_f32 v48, v50, v136, v48
  v_fma_f32 v49, v51, v136, v49
  v_cvt_pk_bf16_f32 v70, v48, v49
  v_lshlrev_b32 v52, 16, v71
  v_and_b32 v53, s25, v71
  v_lshlrev_b32 v54, 16, v79
  v_and_b32 v55, s25, v79
  v_mul_f32 v52, v52, v132
  v_mul_f32 v53, v53, v132
  v_fma_f32 v52, v54, v136, v52
  v_fma_f32 v53, v55, v136, v53
  v_cvt_pk_bf16_f32 v71, v52, v53
  s_add_u32 s24, s12, 81920
  buffer_load_dwordx4 v[112:115], v31, s[56:59], s24 offen offset:0 sc1
  buffer_load_dwordx4 v[116:119], v31, s[56:59], s24 offen offset:1024 sc1
  s_add_u32 s24, s12, 114688
  buffer_load_dwordx4 v[120:123], v31, s[56:59], s24 offen offset:0 sc1
  buffer_load_dwordx4 v[124:127], v31, s[56:59], s24 offen offset:1024 sc1
  s_waitcnt vmcnt(8)
  v_lshlrev_b32 v40, 16, v80
  v_and_b32 v41, s25, v80
  s_waitcnt lgkmcnt(12)
  v_mfma_f32_32x32x16_bf16 a[0:15], a[80:83], v[64:67], 0
  ds_read_b64_tr_b16 a[108:109], v16 offset:4096
  ds_read_b64_tr_b16 a[110:111], v17 offset:4096
  v_lshlrev_b32 v42, 16, v88
  v_and_b32 v43, s25, v88
  v_mul_f32 v40, v40, v133
  v_mul_f32 v41, v41, v133
  v_fma_f32 v40, v42, v137, v40
  v_fma_f32 v41, v43, v137, v41
  v_cvt_pk_bf16_f32 v80, v40, v41
  s_waitcnt lgkmcnt(12)
  v_mfma_f32_32x32x16_bf16 a[0:15], a[84:87], v[68:71], a[0:15]
  ds_read_b64_tr_b16 a[80:81], v33 offset:0
  ds_read_b64_tr_b16 a[82:83], v33 offset:256
  v_lshlrev_b32 v44, 16, v81
  v_and_b32 v45, s25, v81
  v_lshlrev_b32 v46, 16, v89
  v_and_b32 v47, s25, v89
  v_mul_f32 v44, v44, v133
  v_mul_f32 v45, v45, v133
  v_fma_f32 v44, v46, v137, v44
  s_waitcnt lgkmcnt(12)
  v_mfma_f32_32x32x16_bf16 a[16:31], a[88:91], v[64:67], 0
  ds_read_b64_tr_b16 a[84:85], v33 offset:512
  ds_read_b64_tr_b16 a[86:87], v33 offset:768
  v_fma_f32 v45, v47, v137, v45
  v_cvt_pk_bf16_f32 v81, v44, v45
  v_lshlrev_b32 v48, 16, v82
  v_and_b32 v49, s25, v82
  v_lshlrev_b32 v50, 16, v90
  v_and_b32 v51, s25, v90
  v_mul_f32 v48, v48, v133
  s_waitcnt lgkmcnt(12)
  v_mfma_f32_32x32x16_bf16 a[16:31], a[92:95], v[68:71], a[16:31]
  ds_read_b64_tr_b16 a[88:89], v10 offset:32768
  ds_read_b64_tr_b16 a[90:91], v11 offset:32768
  v_mul_f32 v49, v49, v133
  v_fma_f32 v48, v50, v137, v48
  v_fma_f32 v49, v51, v137, v49
  v_cvt_pk_bf16_f32 v82, v48, v49
  v_lshlrev_b32 v52, 16, v83
  v_and_b32 v53, s25, v83
  v_lshlrev_b32 v54, 16, v91
  s_waitcnt lgkmcnt(12)
  v_mfma_f32_32x32x16_bf16 a[32:47], a[96:99], v[64:67], 0
  ds_read_b64_tr_b16 a[92:93], v10 offset:36864
  ds_read_b64_tr_b16 a[94:95], v11 offset:36864
  v_and_b32 v55, s25, v91
  v_mul_f32 v52, v52, v133
  v_mul_f32 v53, v53, v133
  v_fma_f32 v52, v54, v137, v52
  v_fma_f32 v53, v55, v137, v53
  v_cvt_pk_bf16_f32 v83, v52, v53
  v_lshlrev_b32 v40, 16, v84
  s_waitcnt lgkmcnt(12)
  v_mfma_f32_32x32x16_bf16 a[32:47], a[100:103], v[68:71], a[32:47]
  ds_read_b64_tr_b16 a[96:97], v12 offset:32768
  ds_read_b64_tr_b16 a[98:99], v13 offset:32768
  v_and_b32 v41, s25, v84
  v_lshlrev_b32 v42, 16, v92
  v_and_b32 v43, s25, v92
  v_mul_f32 v40, v40, v133
  v_mul_f32 v41, v41, v133
  v_fma_f32 v40, v42, v137, v40
  v_fma_f32 v41, v43, v137, v41
  s_waitcnt lgkmcnt(12)
  v_mfma_f32_32x32x16_bf16 a[48:63], a[104:107], v[64:67], 0
  ds_read_b64_tr_b16 a[100:101], v12 offset:36864
  ds_read_b64_tr_b16 a[102:103], v13 offset:36864
  v_cvt_pk_bf16_f32 v84, v40, v41
  v_lshlrev_b32 v44, 16, v85
  v_and_b32 v45, s25, v85
  v_lshlrev_b32 v46, 16, v93
  v_and_b32 v47, s25, v93
  v_mul_f32 v44, v44, v133
  v_mul_f32 v45, v45, v133
  s_waitcnt lgkmcnt(12)
  v_mfma_f32_32x32x16_bf16 a[48:63], a[108:111], v[68:71], a[48:63]
  ds_read_b64_tr_b16 a[104:105], v14 offset:32768
  ds_read_b64_tr_b16 a[106:107], v15 offset:32768
  v_fma_f32 v44, v46, v137, v44
  v_fma_f32 v45, v47, v137, v45
  v_cvt_pk_bf16_f32 v85, v44, v45
  v_lshlrev_b32 v48, 16, v86
  v_and_b32 v49, s25, v86
  v_lshlrev_b32 v50, 16, v94
  v_and_b32 v51, s25, v94
  s_waitcnt lgkmcnt(12)
  v_mfma_f32_32x32x16_bf16 a[64:79], a[80:83], v[64:67], 0
  ds_read_b64_tr_b16 a[108:109], v14 offset:36864
  ds_read_b64_tr_b16 a[110:111], v15 offset:36864
  v_mul_f32 v48, v48, v133
  v_mul_f32 v49, v49, v133
  v_fma_f32 v48, v50, v137, v48
  v_fma_f32 v49, v51, v137, v49
  v_cvt_pk_bf16_f32 v86, v48, v49
  v_lshlrev_b32 v52, 16, v87
  v_and_b32 v53, s25, v87
  s_waitcnt lgkmcnt(12)
  v_mfma_f32_32x32x16_bf16 a[64:79], a[84:87], v[68:71], a[64:79]
  ds_read_b64_tr_b16 a[80:81], v16 offset:32768
  ds_read_b64_tr_b16 a[82:83], v17 offset:32768
  v_lshlrev_b32 v54, 16, v95
  v_and_b32 v55, s25, v95
  v_mul_f32 v52, v52, v133
  v_mul_f32 v53, v53, v133
  v_fma_f32 v52, v54, v137, v52
  v_fma_f32 v53, v55, v137, v53
  v_cvt_pk_bf16_f32 v87, v52, v53
  s_waitcnt vmcnt(4)
  v_lshlrev_b32 v40, 16, v96
  v_and_b32 v41, s25, v96
  s_waitcnt lgkmcnt(12)
  v_mfma_f32_32x32x16_bf16 a[0:15], a[88:91], v[80:83], a[0:15]
  ds_read_b64_tr_b16 a[84:85], v16 offset:36864
  ds_read_b64_tr_b16 a[86:87], v17 offset:36864
  v_lshlrev_b32 v42, 16, v104
  v_and_b32 v43, s25, v104
  v_mul_f32 v40, v40, v134
  v_mul_f32 v41, v41, v134
  v_fma_f32 v40, v42, v138, v40
  v_fma_f32 v41, v43, v138, v41
  v_cvt_pk_bf16_f32 v96, v40, v41
  s_waitcnt lgkmcnt(12)
  v_mfma_f32_32x32x16_bf16 a[0:15], a[92:95], v[84:87], a[0:15]
  ds_read_b64_tr_b16 a[88:89], v33 offset:4096
  ds_read_b64_tr_b16 a[90:91], v33 offset:4352
  v_lshlrev_b32 v44, 16, v97
  v_and_b32 v45, s25, v97
  v_lshlrev_b32 v46, 16, v105
  v_and_b32 v47, s25, v105
  v_mul_f32 v44, v44, v134
  v_mul_f32 v45, v45, v134
  v_fma_f32 v44, v46, v138, v44
  s_waitcnt lgkmcnt(12)
  v_mfma_f32_32x32x16_bf16 a[16:31], a[96:99], v[80:83], a[16:31]
  ds_read_b64_tr_b16 a[92:93], v33 offset:4608
  ds_read_b64_tr_b16 a[94:95], v33 offset:4864
  v_fma_f32 v45, v47, v138, v45
  v_cvt_pk_bf16_f32 v97, v44, v45
  v_lshlrev_b32 v48, 16, v98
  v_and_b32 v49, s25, v98
  v_lshlrev_b32 v50, 16, v106
  v_and_b32 v51, s25, v106
  v_mul_f32 v48, v48, v134
  s_waitcnt lgkmcnt(12)
  v_mfma_f32_32x32x16_bf16 a[16:31], a[100:103], v[84:87], a[16:31]
  ds_read_b64_tr_b16 a[96:97], v2 offset:0
  ds_read_b64_tr_b16 a[98:99], v3 offset:0
  v_mul_f32 v49, v49, v134
  v_fma_f32 v48, v50, v138, v48
  v_fma_f32 v49, v51, v138, v49
  v_cvt_pk_bf16_f32 v98, v48, v49
  v_lshlrev_b32 v52, 16, v99
  v_and_b32 v53, s25, v99
  v_lshlrev_b32 v54, 16, v107
  s_waitcnt lgkmcnt(12)
  v_mfma_f32_32x32x16_bf16 a[32:47], a[104:107], v[80:83], a[32:47]
  ds_read_b64_tr_b16 a[100:101], v2 offset:4096
  ds_read_b64_tr_b16 a[102:103], v3 offset:4096
  v_and_b32 v55, s25, v107
  v_mul_f32 v52, v52, v134
  v_mul_f32 v53, v53, v134
  v_fma_f32 v52, v54, v138, v52
  v_fma_f32 v53, v55, v138, v53
  v_cvt_pk_bf16_f32 v99, v52, v53
  v_lshlrev_b32 v40, 16, v100
  s_waitcnt lgkmcnt(12)
  v_mfma_f32_32x32x16_bf16 a[32:47], a[108:111], v[84:87], a[32:47]
  ds_read_b64_tr_b16 a[104:105], v4 offset:0
  ds_read_b64_tr_b16 a[106:107], v5 offset:0
  v_and_b32 v41, s25, v100
  v_lshlrev_b32 v42, 16, v108
  v_and_b32 v43, s25, v108
  v_mul_f32 v40, v40, v134
  v_mul_f32 v41, v41, v134
  v_fma_f32 v40, v42, v138, v40
  v_fma_f32 v41, v43, v138, v41
  s_waitcnt lgkmcnt(12)
  v_mfma_f32_32x32x16_bf16 a[48:63], a[80:83], v[80:83], a[48:63]
  ds_read_b64_tr_b16 a[108:109], v4 offset:4096
  ds_read_b64_tr_b16 a[110:111], v5 offset:4096
  v_cvt_pk_bf16_f32 v100, v40, v41
  v_lshlrev_b32 v44, 16, v101
  v_and_b32 v45, s25, v101
  v_lshlrev_b32 v46, 16, v109
  v_and_b32 v47, s25, v109
  v_mul_f32 v44, v44, v134
  v_mul_f32 v45, v45, v134
  s_waitcnt lgkmcnt(12)
  v_mfma_f32_32x32x16_bf16 a[48:63], a[84:87], v[84:87], a[48:63]
  ds_read_b64_tr_b16 a[80:81], v6 offset:0
  ds_read_b64_tr_b16 a[82:83], v7 offset:0
  v_fma_f32 v44, v46, v138, v44
  v_fma_f32 v45, v47, v138, v45
  v_cvt_pk_bf16_f32 v101, v44, v45
  v_lshlrev_b32 v48, 16, v102
  v_and_b32 v49, s25, v102
  v_lshlrev_b32 v50, 16, v110
  v_and_b32 v51, s25, v110
  s_waitcnt lgkmcnt(12)
  v_mfma_f32_32x32x16_bf16 a[64:79], a[88:91], v[80:83], a[64:79]
  ds_read_b64_tr_b16 a[84:85], v6 offset:4096
  ds_read_b64_tr_b16 a[86:87], v7 offset:4096
  v_mul_f32 v48, v48, v134
  v_mul_f32 v49, v49, v134
  v_fma_f32 v48, v50, v138, v48
  v_fma_f32 v49, v51, v138, v49
  v_cvt_pk_bf16_f32 v102, v48, v49
  v_lshlrev_b32 v52, 16, v103
  v_and_b32 v53, s25, v103
  s_waitcnt lgkmcnt(12)
  v_mfma_f32_32x32x16_bf16 a[64:79], a[92:95], v[84:87], a[64:79]
  ds_read_b64_tr_b16 a[88:89], v8 offset:0
  ds_read_b64_tr_b16 a[90:91], v9 offset:0
  v_lshlrev_b32 v54, 16, v111
  v_and_b32 v55, s25, v111
  v_mul_f32 v52, v52, v134
  v_mul_f32 v53, v53, v134
  v_fma_f32 v52, v54, v138, v52
  v_fma_f32 v53, v55, v138, v53
  v_cvt_pk_bf16_f32 v103, v52, v53
  s_waitcnt vmcnt(0)
  v_lshlrev_b32 v40, 16, v112
  v_and_b32 v41, s25, v112
  s_waitcnt lgkmcnt(12)
  v_mfma_f32_32x32x16_bf16 a[0:15], a[96:99], v[96:99], a[0:15]
  ds_read_b64_tr_b16 a[92:93], v8 offset:4096
  ds_read_b64_tr_b16 a[94:95], v9 offset:4096
  v_lshlrev_b32 v42, 16, v120
  v_and_b32 v43, s25, v120
  v_mul_f32 v40, v40, v135
  v_mul_f32 v41, v41, v135
  v_fma_f32 v40, v42, v139, v40
  v_fma_f32 v41, v43, v139, v41
  v_cvt_pk_bf16_f32 v112, v40, v41
  s_waitcnt lgkmcnt(12)
  v_mfma_f32_32x32x16_bf16 a[0:15], a[100:103], v[100:103], a[0:15]
  ds_read_b64_tr_b16 a[96:97], v33 offset:8192
  ds_read_b64_tr_b16 a[98:99], v33 offset:8448
  v_lshlrev_b32 v44, 16, v113
  v_and_b32 v45, s25, v113
  v_lshlrev_b32 v46, 16, v121
  v_and_b32 v47, s25, v121
  v_mul_f32 v44, v44, v135
  v_mul_f32 v45, v45, v135
  v_fma_f32 v44, v46, v139, v44
  s_waitcnt lgkmcnt(12)
  v_mfma_f32_32x32x16_bf16 a[16:31], a[104:107], v[96:99], a[16:31]
  ds_read_b64_tr_b16 a[100:101], v33 offset:8704
  ds_read_b64_tr_b16 a[102:103], v33 offset:8960
  v_fma_f32 v45, v47, v139, v45
  v_cvt_pk_bf16_f32 v113, v44, v45
  v_lshlrev_b32 v48, 16, v114
  v_and_b32 v49, s25, v114
  v_lshlrev_b32 v50, 16, v122
  v_and_b32 v51, s25, v122
  v_mul_f32 v48, v48, v135
  s_waitcnt lgkmcnt(12)
  v_mfma_f32_32x32x16_bf16 a[16:31], a[108:111], v[100:103], a[16:31]
  ds_read_b64_tr_b16 a[104:105], v2 offset:32768
  ds_read_b64_tr_b16 a[106:107], v3 offset:32768
  v_mul_f32 v49, v49, v135
  v_fma_f32 v48, v50, v139, v48
  v_fma_f32 v49, v51, v139, v49
  v_cvt_pk_bf16_f32 v114, v48, v49
  v_lshlrev_b32 v52, 16, v115
  v_and_b32 v53, s25, v115
  v_lshlrev_b32 v54, 16, v123
  s_waitcnt lgkmcnt(12)
  v_mfma_f32_32x32x16_bf16 a[32:47], a[80:83], v[96:99], a[32:47]
  ds_read_b64_tr_b16 a[108:109], v2 offset:36864
  ds_read_b64_tr_b16 a[110:111], v3 offset:36864
  v_and_b32 v55, s25, v123
  v_mul_f32 v52, v52, v135
  v_mul_f32 v53, v53, v135
  v_fma_f32 v52, v54, v139, v52
  v_fma_f32 v53, v55, v139, v53
  v_cvt_pk_bf16_f32 v115, v52, v53
  v_lshlrev_b32 v40, 16, v116
  s_waitcnt lgkmcnt(12)
  v_mfma_f32_32x32x16_bf16 a[32:47], a[84:87], v[100:103], a[32:47]
  ds_read_b64_tr_b16 a[80:81], v4 offset:32768
  ds_read_b64_tr_b16 a[82:83], v5 offset:32768
  v_and_b32 v41, s25, v116
  v_lshlrev_b32 v42, 16, v124
  v_and_b32 v43, s25, v124
  v_mul_f32 v40, v40, v135
  v_mul_f32 v41, v41, v135
  v_fma_f32 v40, v42, v139, v40
  v_fma_f32 v41, v43, v139, v41
  s_waitcnt lgkmcnt(12)
  v_mfma_f32_32x32x16_bf16 a[48:63], a[88:91], v[96:99], a[48:63]
  ds_read_b64_tr_b16 a[84:85], v4 offset:36864
  ds_read_b64_tr_b16 a[86:87], v5 offset:36864
  v_cvt_pk_bf16_f32 v116, v40, v41
  v_lshlrev_b32 v44, 16, v117
  v_and_b32 v45, s25, v117
  v_lshlrev_b32 v46, 16, v125
  v_and_b32 v47, s25, v125
  v_mul_f32 v44, v44, v135
  v_mul_f32 v45, v45, v135
  s_waitcnt lgkmcnt(12)
  v_mfma_f32_32x32x16_bf16 a[48:63], a[92:95], v[100:103], a[48:63]
  ds_read_b64_tr_b16 a[88:89], v6 offset:32768
  ds_read_b64_tr_b16 a[90:91], v7 offset:32768
  v_fma_f32 v44, v46, v139, v44
  v_fma_f32 v45, v47, v139, v45
  v_cvt_pk_bf16_f32 v117, v44, v45
  v_lshlrev_b32 v48, 16, v118
  v_and_b32 v49, s25, v118
  v_lshlrev_b32 v50, 16, v126
  v_and_b32 v51, s25, v126
  s_waitcnt lgkmcnt(12)
  v_mfma_f32_32x32x16_bf16 a[64:79], a[96:99], v[96:99], a[64:79]
  ds_read_b64_tr_b16 a[92:93], v6 offset:36864
  ds_read_b64_tr_b16 a[94:95], v7 offset:36864
  v_mul_f32 v48, v48, v135
  v_mul_f32 v49, v49, v135
  v_fma_f32 v48, v50, v139, v48
  v_fma_f32 v49, v51, v139, v49
  v_cvt_pk_bf16_f32 v118, v48, v49
  v_lshlrev_b32 v52, 16, v119
  v_and_b32 v53, s25, v119
  s_waitcnt lgkmcnt(12)
  v_mfma_f32_32x32x16_bf16 a[64:79], a[100:103], v[100:103], a[64:79]
  ds_read_b64_tr_b16 a[96:97], v8 offset:32768
  ds_read_b64_tr_b16 a[98:99], v9 offset:32768
  v_lshlrev_b32 v54, 16, v127
  v_and_b32 v55, s25, v127
  v_mul_f32 v52, v52, v135
  v_mul_f32 v53, v53, v135
  v_fma_f32 v52, v54, v139, v52
  v_fma_f32 v53, v55, v139, v53
  v_cvt_pk_bf16_f32 v119, v52, v53
  s_barrier
  s_waitcnt lgkmcnt(12)
  v_mfma_f32_32x32x16_bf16 a[0:15], a[104:107], v[112:115], a[0:15]
  ds_read_b64_tr_b16 a[100:101], v8 offset:36864
  ds_read_b64_tr_b16 a[102:103], v9 offset:36864
  s_waitcnt lgkmcnt(12)
  v_mfma_f32_32x32x16_bf16 a[0:15], a[108:111], v[116:119], a[0:15]
  ds_read_b64_tr_b16 a[104:105], v33 offset:12288
  ds_read_b64_tr_b16 a[106:107], v33 offset:12544
  s_waitcnt lgkmcnt(12)
  v_mfma_f32_32x32x16_bf16 a[16:31], a[80:83], v[112:115], a[16:31]
  ds_read_b64_tr_b16 a[108:109], v33 offset:12800
  ds_read_b64_tr_b16 a[110:111], v33 offset:13056
  s_waitcnt lgkmcnt(0)
  v_mfma_f32_32x32x16_bf16 a[16:31], a[84:87], v[116:119], a[16:31]
  v_mfma_f32_32x32x16_bf16 a[32:47], a[88:91], v[112:115], a[32:47]
  v_mfma_f32_32x32x16_bf16 a[32:47], a[92:95], v[116:119], a[32:47]
  v_mfma_f32_32x32x16_bf16 a[48:63], a[96:99], v[112:115], a[48:63]
  v_mfma_f32_32x32x16_bf16 a[48:63], a[100:103], v[116:119], a[48:63]
  v_mfma_f32_32x32x16_bf16 a[64:79], a[104:107], v[112:115], a[64:79]
  v_mfma_f32_32x32x16_bf16 a[64:79], a[108:111], v[116:119], a[64:79]
  s_nop 4
  ds_write_b128 v140, a[4:7] offset:0
  ds_write_b128 v141, a[8:11] offset:0
  ds_write_b128 v142, a[12:15] offset:0
  ds_write_b128 v140, a[20:23] offset:1024
  ds_write_b128 v141, a[24:27] offset:1024
  ds_write_b128 v142, a[28:31] offset:1024
  ds_write_b128 v140, a[36:39] offset:2048
  ds_write_b128 v141, a[40:43] offset:2048
  ds_write_b128 v142, a[44:47] offset:2048
  ds_write_b128 v140, a[52:55] offset:3072
  ds_write_b128 v141, a[56:59] offset:3072
  ds_write_b128 v142, a[60:63] offset:3072
  ds_write_b128 v21, a[64:67] offset:0
  ds_write_b128 v21, a[68:71] offset:4096
  v_bfe_u32 v39, v1, 3, 2
  v_mul_u32_u24 v39, 40960, v39
  v_lshrrev_b32 v29, 5, v1
  v_lshl_add_u32 v39, v29, 7, v39
  v_and_b32 v29, 7, v1
  v_lshl_add_u32 v39, v29, 4, v39
  s_lshl_b32 s8, s17, 8
  v_add_u32 v39, s8, v39
  s_lshl_b32 s9, s22, 6
  s_add_u32 s9, s9, s4
  s_mul_i32 s9, s9, 5120
  s_mul_i32 s8, s18, 163840
  s_add_u32 s9, s9, s8
  s_add_u32 s9, s9, 0x800000
  s_add_u32 s25, s9, 4096
  s_lshl_b32 s8, s18, 11
  s_sub_u32 s10, s9, s8
  s_add_u32 s9, s9, s8
  v_accvgpr_read_b32 v40, a0
  v_accvgpr_read_b32 v41, a1
  v_accvgpr_read_b32 v42, a2
  v_accvgpr_read_b32 v43, a3
  v_accvgpr_read_b32 v44, a16
  v_accvgpr_read_b32 v45, a17
  v_accvgpr_read_b32 v46, a18
  v_accvgpr_read_b32 v47, a19
  v_accvgpr_read_b32 v48, a32
  v_accvgpr_read_b32 v49, a33
  v_accvgpr_read_b32 v50, a34
  v_accvgpr_read_b32 v51, a35
  v_accvgpr_read_b32 v52, a48
  v_accvgpr_read_b32 v53, a49
  v_accvgpr_read_b32 v54, a50
  v_accvgpr_read_b32 v55, a51
  s_waitcnt lgkmcnt(0)
  s_barrier
  ds_read_b128 v[64:67], v143 offset:0
  ds_read_b128 v[68:71], v143 offset:4096
  ds_read_b128 v[72:75], v143 offset:8192
  ds_read_b128 v[76:79], v143 offset:1024
  ds_read_b128 v[80:83], v143 offset:5120
  ds_read_b128 v[84:87], v143 offset:9216
  ds_read_b128 v[88:91], v143 offset:2048
  ds_read_b128 v[92:95], v143 offset:6144
  ds_read_b128 v[96:99], v143 offset:10240
  ds_read_b128 v[100:103], v143 offset:3072
  ds_read_b128 v[104:107], v143 offset:7168
  ds_read_b128 v[108:111], v143 offset:11264
  ds_read_b128 v[112:115], v22 offset:0
  ds_read_b128 v[116:119], v22 offset:1024
  ds_read_b128 v[120:123], v22 offset:2048
  ds_read_b128 v[124:127], v22 offset:3072
  s_waitcnt lgkmcnt(13)
  v_add_f32 v40, v40, v64
  v_add_f32 v68, v68, v72
  v_add_f32 v41, v41, v65
  v_add_f32 v69, v69, v73
  v_add_f32 v42, v42, v66
  v_add_f32 v70, v70, v74
  v_add_f32 v43, v43, v67
  v_add_f32 v71, v71, v75
  v_add_f32 v40, v40, v68
  v_add_f32 v41, v41, v69
  v_add_f32 v42, v42, v70
  v_add_f32 v43, v43, v71
  buffer_store_dwordx4 v[40:43], v39, s[56:59], s9 offen offset:0 sc1
  s_waitcnt lgkmcnt(10)
  v_add_f32 v44, v44, v76
  v_add_f32 v80, v80, v84
  v_add_f32 v45, v45, v77
  v_add_f32 v81, v81, v85
  v_add_f32 v46, v46, v78
  v_add_f32 v82, v82, v86
  v_add_f32 v47, v47, v79
  v_add_f32 v83, v83, v87
  v_add_f32 v44, v44, v80
  v_add_f32 v45, v45, v81
  v_add_f32 v46, v46, v82
  v_add_f32 v47, v47, v83
  buffer_store_dwordx4 v[44:47], v39, s[56:59], s9 offen offset:1024 sc1
  s_waitcnt lgkmcnt(7)
  v_add_f32 v48, v48, v88
  v_add_f32 v92, v92, v96
  v_add_f32 v49, v49, v89
  v_add_f32 v93, v93, v97
  v_add_f32 v50, v50, v90
  v_add_f32 v94, v94, v98
  v_add_f32 v51, v51, v91
  v_add_f32 v95, v95, v99
  v_add_f32 v48, v48, v92
  v_add_f32 v49, v49, v93
  v_add_f32 v50, v50, v94
  v_add_f32 v51, v51, v95
  buffer_store_dwordx4 v[48:51], v39, s[56:59], s10 offen offset:2048 sc1
  s_waitcnt lgkmcnt(4)
  v_add_f32 v52, v52, v100
  v_add_f32 v104, v104, v108
  v_add_f32 v53, v53, v101
  v_add_f32 v105, v105, v109
  v_add_f32 v54, v54, v102
  v_add_f32 v106, v106, v110
  v_add_f32 v55, v55, v103
  v_add_f32 v107, v107, v111
  v_add_f32 v52, v52, v104
  v_add_f32 v53, v53, v105
  v_add_f32 v54, v54, v106
  v_add_f32 v55, v55, v107
  buffer_store_dwordx4 v[52:55], v39, s[56:59], s10 offen offset:3072 sc1
  s_cmp_ge_u32 s17, 2
  s_cbranch_scc1 L_skip5
  s_waitcnt lgkmcnt(0)
  v_add_f32 v112, v112, v116
  v_add_f32 v120, v120, v124
  v_add_f32 v113, v113, v117
  v_add_f32 v121, v121, v125
  v_add_f32 v114, v114, v118
  v_add_f32 v122, v122, v126
  v_add_f32 v115, v115, v119
  v_add_f32 v123, v123, v127
  v_add_f32 v112, v112, v120
  v_add_f32 v113, v113, v121
  v_add_f32 v114, v114, v122
  v_add_f32 v115, v115, v123
  buffer_store_dwordx4 v[112:115], v39, s[56:59], s25 offen sc1
L_skip5:
  s_lshl_b32 s11, s6, 10
  s_add_u32 s11, s11, s28
  s_add_u32 s11, s11, 4096
  s_lshl_b32 s9, s4, 7
  s_add_u32 s9, s9, s11
  v_mov_b32 v22, 1
  v_lshlrev_b32 v20, 7, v1
  s_waitcnt vmcnt(0) lgkmcnt(0)
  s_barrier
  s_cmp_ge_u32 s3, 5
  s_cbranch_scc1 L_end
  s_cmp_lg_u32 s3, 0
  s_cbranch_scc1 L_h2_other
  s_mov_b64 exec, 1
  buffer_store_dword v22, v23, s[56:59], s9 offen sc1
  s_mov_b64 exec, -1
  s_mov_b32 s23, 0
  s_lshl_b32 s8, 1, s4
  s_andn2_b32 exec_lo, 0xff, s8
  s_mov_b32 exec_hi, 0
L_p2:
  buffer_load_dword v34, v20, s[56:59], s11 offen sc1
  s_add_u32 s23, s23, 1
  s_waitcnt vmcnt(0)
  v_cmp_ne_u32 vcc, 1, v34
  s_cbranch_vccz L_p2_ok
  s_cmp_gt_u32 s23, 32768
  s_cbranch_scc1 L_p2_ok
  s_sleep 2
  s_branch L_p2
L_p2_ok:
  s_mov_b64 exec, -1
L_h2_other:
  v_and_b32 v21, 7, v1
  v_mul_u32_u24 v6, 1152, v21
  v_lshrrev_b32 v21, 3, v1
  v_lshl_add_u32 v6, v21, 3, v6
  s_lshl_b32 s9, s22, 3
  s_add_u32 s9, s9, s4
  s_mul_i32 s9, s9, 40960
  s_add_u32 s9, s9, 0x800000
  s_lshl_b32 s8, s3, 10
  s_add_u32 s9, s9, s8
  s_lshl_b32 s10, s5, 6
  s_lshl_b32 s25, s4, 3
  s_add_u32 s10, s10, s25
  s_mul_i32 s10, s10, 576
  s_add_u32 s10, s10, s19
  s_lshl_b32 s10, s10, 1
  s_lshl_b32 s8, s3, 6
  s_add_u32 s10, s10, s8
  s_barrier
  s_cmp_lg_u32 s3, 4
  s_cbranch_scc1 L_full
  s_mov_b32 exec_hi, 0
L_full:
  s_add_u32 s8, s9, 0
  buffer_load_dwordx4 v[48:51], v31, s[56:59], s8 offen sc1
  s_add_u32 s8, s9, 5120
  buffer_load_dwordx4 v[52:55], v31, s[56:59], s8 offen sc1
  s_add_u32 s8, s9, 10240
  buffer_load_dwordx4 v[56:59], v31, s[56:59], s8 offen sc1
  s_add_u32 s8, s9, 15360
  buffer_load_dwordx4 v[60:63], v31, s[56:59], s8 offen sc1
  s_add_u32 s8, s9, 20480
  buffer_load_dwordx4 v[64:67], v31, s[56:59], s8 offen sc1
  s_add_u32 s8, s9, 25600
  buffer_load_dwordx4 v[68:71], v31, s[56:59], s8 offen sc1
  s_add_u32 s8, s9, 30720
  buffer_load_dwordx4 v[72:75], v31, s[56:59], s8 offen sc1
  s_add_u32 s8, s9, 35840
  buffer_load_dwordx4 v[76:79], v31, s[56:59], s8 offen sc1
  s_waitcnt vmcnt(0)
  v_add_f32 v48, v48, v52
  v_add_f32 v56, v56, v60
  v_add_f32 v64, v64, v68
  v_add_f32 v72, v72, v76
  v_add_f32 v48, v48, v56
  v_add_f32 v64, v64, v72
  v_add_f32 v48, v48, v64
  v_add_f32 v49, v49, v53
  v_add_f32 v57, v57, v61
  v_add_f32 v65, v65, v69
  v_add_f32 v73, v73, v77
  v_add_f32 v49, v49, v57
  v_add_f32 v65, v65, v73
  v_add_f32 v49, v49, v65
  v_add_f32 v50, v50, v54
  v_add_f32 v58, v58, v62
  v_add_f32 v66, v66, v70
  v_add_f32 v74, v74, v78
  v_add_f32 v50, v50, v58
  v_add_f32 v66, v66, v74
  v_add_f32 v50, v50, v66
  v_add_f32 v51, v51, v55
  v_add_f32 v59, v59, v63
  v_add_f32 v67, v67, v71
  v_add_f32 v75, v75, v79
  v_add_f32 v51, v51, v59
  v_add_f32 v67, v67, v75
  v_add_f32 v51, v51, v67
  v_cvt_pk_bf16_f32 v4, v48, v49
  v_cvt_pk_bf16_f32 v5, v50, v51
  buffer_store_dwordx2 v[4:5], v6, s[52:55], s10 offen
  s_mov_b64 exec, -1
L_end:
L_done:
  s_endpgm
.section .rodata,"a"
.p2align 6
.amdhsa_kernel standalone__gqa_block_cached__near_ridge_kernel
  .amdhsa_next_free_vgpr 256
  .amdhsa_next_free_sgpr 102
  .amdhsa_accum_offset 144
  .amdhsa_group_segment_fixed_size 0
  .amdhsa_kernarg_size 64
  .amdhsa_user_sgpr_count 2
  .amdhsa_user_sgpr_kernarg_segment_ptr 1
  .amdhsa_system_sgpr_workgroup_id_x 1
  .amdhsa_float_denorm_mode_32 3
  .amdhsa_float_denorm_mode_16_64 3
.end_amdhsa_kernel
```
